```python
import torch

def _softmax(x, axis=-1):
    return torch.softmax(x, dim=axis)
def _gelu(x):
    return torch.nn.functional.gelu(x, approximate="tanh")
def _silu(x):
    return torch.nn.functional.silu(x)
def _sigmoid(x):
    return torch.sigmoid(x)
def _layernorm(x, axis=-1, eps=1e-5):
    m = x.mean(dim=axis, keepdim=True)
    v = x.var(dim=axis, keepdim=True, unbiased=False)
    return (x - m) / torch.sqrt(v + eps)
def _scatter_add(tgt, idx, src, axis=0):
    return tgt.clone().index_add_(axis, idx, src)
def _segment_sum(src, seg, n):
    out = torch.zeros((n,) + src.shape[1:], dtype=src.dtype)
    return out.index_add_(0, seg, src)
def _pad(x, pw):
    flat = tuple(v for pair in reversed(pw) for v in pair)
    return torch.nn.functional.pad(x, flat)

kernel_name = 'interleave_layers__sliding_local_dilated__geglu_ffn__prompt'

def setup_inputs():

    _w = (lambda a: (lambda t: t.to(torch.bfloat16) if t.is_floating_point() else t)(torch.as_tensor(a)))
    def _A_setup():
        B, S, D = 1, 2048, 512
        return {
            "x": _w((lambda *s: torch.randn(*s, dtype=torch.bfloat16) * 0.05)(B, S, D)),
            "wqkv": _w((lambda *s: torch.randn(*s, dtype=torch.bfloat16) * 0.05)(D, 3 * D)),
            "wo": _w((lambda *s: torch.randn(*s, dtype=torch.bfloat16) * 0.05)(D, D)),
        }
    _A_in = _A_setup()

    def _B_setup():
        B, S, D, F = 1, 2048, 512, 1376
        return {
            "x": _w((lambda *s: torch.randn(*s, dtype=torch.bfloat16) * 0.05)(B, S, D)),
            "w_gate": _w((lambda *s: torch.randn(*s, dtype=torch.bfloat16) * 0.05)(D, F)),
            "w_up": _w((lambda *s: torch.randn(*s, dtype=torch.bfloat16) * 0.05)(D, F)),
            "w_down": _w((lambda *s: torch.randn(*s, dtype=torch.bfloat16) * 0.05)(F, D)),
        }
    _B_in = _B_setup()

    return {
        "A_x": _A_in["x"],
        "A_wqkv": _A_in["wqkv"],
        "A_wo": _A_in["wo"],
        "B_x": _B_in["x"],
        "B_w_gate": _B_in["w_gate"],
        "B_w_up": _B_in["w_up"],
        "B_w_down": _B_in["w_down"],
    }

def reference(A_x, A_wqkv, A_wo, B_x, B_w_gate, B_w_up, B_w_down):
    def _A_ref(x, wqkv, wo):
        B, S, D = x.shape
        H = 32; Dh = D // H
        W, dil = 8, 2
        qkv = (lambda x, *d: x.permute(*d))((x @ wqkv).reshape(B, S, 3, H, Dh), 2, 0, 3, 1, 4)
        q, k, v = qkv[0], qkv[1], qkv[2]
        scale = Dh ** -0.5
        pos = torch.arange(S)
        off = torch.arange(W) * dil
        idx = pos[:, None] - off[None, :]
        mask = idx >= 0
        idx_c = torch.where(mask, idx, 0).reshape(-1)
        kg = k[:, :, idx_c, :].reshape(B, H, S, W, Dh)
        vg = v[:, :, idx_c, :].reshape(B, H, S, W, Dh)
        logits = torch.einsum("bhsd,bhswd->bhsw", q, kg) * scale
        logits = torch.where(mask[None, None, :, :], logits, -1e9)
        attn = _softmax(logits, axis=-1)
        o = torch.einsum("bhsw,bhswd->bhsd", attn, vg)
        return (lambda x, *d: x.permute(*d))(o, 0, 2, 1, 3).reshape(B, S, D) @ wo

    def _B_ref(x, w_gate, w_up, w_down):
        return (_gelu(x @ w_gate) * (x @ w_up)) @ w_down

    x = A_x
    x = x + _A_ref(_layernorm(x, axis=-1), A_wqkv, A_wo)
    x = x + _B_ref(_layernorm(x, axis=-1), B_w_gate, B_w_up, B_w_down)
    x = x + _A_ref(_layernorm(x, axis=-1), A_wqkv, A_wo)
    x = x + _B_ref(_layernorm(x, axis=-1), B_w_gate, B_w_up, B_w_down)
    return x
```

```asm
; @launch grid=(256,1,1) block=(512,1,1) lds=163840
.amdgcn_target "amdgcn-amd-amdhsa--gfx950"
.text
.globl interleave_layers__sliding_local_dilated__geglu_ffn__prompt_kernel
.p2align 8
.type interleave_layers__sliding_local_dilated__geglu_ffn__prompt_kernel,@function
interleave_layers__sliding_local_dilated__geglu_ffn__prompt_kernel:
    s_cmp_ge_u32 s2, 256
    s_cbranch_scc1 L_end
    s_load_dwordx4 s[4:7], s[0:1], 0
    s_load_dwordx2 s[8:9], s[0:1], 16
    s_load_dwordx4 s[12:15], s[0:1], 32
    s_load_dwordx2 s[10:11], s[0:1], 48
    s_load_dwordx2 s[16:17], s[0:1], 56
    s_load_dwordx2 s[18:19], s[0:1], 72
    v_lshrrev_b32 v1, 6, v0
    v_and_b32 v0, 63, v0
    v_readfirstlane_b32 s20, v1
    s_and_b32 s25, s2, 7
    s_lshr_b32 s26, s2, 3
    s_lshr_b32 s27, s26, 4
    s_lshl_b32 s21, s25, 1
    s_add_u32 s21, s21, s27
    s_and_b32 s22, s26, 15
    s_lshl_b32 s25, s21, 21
    s_waitcnt lgkmcnt(0)
    s_add_u32 s18, s18, s25
    s_addc_u32 s19, s19, 0
    s_mov_b32 s25, 768
    s_mov_b32 s26, 2097920
    s_load_dword s23, s[18:19], s25
    s_load_dword s24, s[18:19], s26
    s_mov_b32 s28, s18
    s_mov_b32 s29, s19
    s_mov_b32 s30, 4194304
    s_mov_b32 s31, 0x00020000
    v_lshlrev_b32 v1, 4, v0
    s_getpc_b64 s[96:97]
L_pc:
    s_lshr_b32 s25, s2, 3
    s_lshl_b32 s25, s25, 3
    s_add_u32 s25, s25, s20
    s_and_b32 s25, s25, 63
    s_lshl_b32 s25, s25, 10
    v_add_u32 v2, s25, v1
    v_min_u32 v2, CODE_LAST, v2
    global_load_dwordx4 v[252:255], v2, s[96:97]
    s_cmp_ge_u32 s20, 4
    s_cbranch_scc1 L_helper
    s_nop 4
    s_setprio 2
    s_mov_b32 s40, s4
    s_mov_b32 s41, s5
    s_mov_b32 s42, 2097152
    s_mov_b32 s43, 0x00020000
    s_mov_b32 s44, s16
    s_mov_b32 s45, s17
    s_mov_b32 s46, 2097152
    s_mov_b32 s47, 0x00020000
    s_mov_b32 s32, s18
    s_mov_b32 s33, s19
    s_mov_b32 s34, 0
    s_mov_b32 s35, 0x00020000
    s_mov_b32 s36, s18
    s_mov_b32 s37, s19
    s_mov_b32 s38, 4194304
    s_mov_b32 s39, 0x00020000
    s_and_b32 s50, s20, 1
    s_lshr_b32 s51, s20, 1
    s_lshr_b32 s52, s22, 3
    s_and_b32 s53, s22, 7
    s_mov_b32 s54, s20
    s_lshl_b32 s55, s52, 1
    s_add_u32 s55, s55, s50
    s_lshl_b32 s98, s21, 2
    s_add_u32 s98, s98, s55
    v_lshrrev_b32 v2, 5, v0
    v_lshlrev_b32 v2, 9, v2
    v_and_b32 v7, 15, v0
    v_lshrrev_b32 v7, 2, v7
    v_lshl_add_u32 v2, v7, 6, v2
    v_bfe_u32 v7, v0, 4, 1
    v_lshl_add_u32 v2, v7, 5, v2
    v_and_b32 v7, 3, v0
    v_lshl_add_u32 v2, v7, 3, v2
    s_mov_b32 s57, 0
    v_lshlrev_b32 v3, 2, v0
    v_add_u32 v3, s57, v3
    s_lshl_b32 s58, s22, 4
    s_lshl_b32 s59, s20, 2
    s_add_u32 s58, s58, s59
    s_add_u32 s58, s58, s57
    v_mov_b32 v4, s58
    v_mov_b32 v30, 0
    v_mov_b32 v31, 0
    v_mov_b32 v34, 0
    v_mov_b32 v35, 0
    v_mov_b32 v38, 0
    v_mov_b32 v39, 0
    v_mov_b32 v8, 0
    s_mov_b64 exec, 1
    buffer_load_dword v120, v8, s[44:47], 0 offen
    buffer_load_dword v121, v8, s[28:31], 0 offen offset:2048
    s_mov_b64 exec, -1
    v_lshrrev_b32 v8, 2, v0
    v_and_b32 v9, 3, v0
    s_lshl_b32 s57, s22, 6
    v_lshlrev_b32 v10, 4, v9
    v_add_u32 v10, s57, v10
    s_lshl_b32 s57, s21, 7
    s_lshl_b32 s58, s20, 5
    s_add_u32 s58, s58, s57
    v_add_u32 v11, s58, v8
    v_lshl_add_u32 v11, v11, 10, v10
    buffer_load_dwordx4 v[16:19], v11, s[40:43], 0 offen
    v_add_u32 v12, 0x4000, v11
    buffer_load_dwordx4 v[20:23], v12, s[40:43], 0 offen
    s_sub_i32 s59, s57, 16
    v_add_u32 v12, s59, v8
    v_max_i32 v12, 0, v12
    v_lshl_add_u32 v12, v12, 10, v10
    buffer_load_dwordx4 v[24:27], v12, s[40:43], 0 offen
    s_waitcnt lgkmcnt(0)
    s_getreg_b32 s60, hwreg(HW_REG_XCC_ID)
    s_and_b32 s60, s60, 7
    s_add_u32 s60, s60, s23
    s_add_u32 s89, s60, 16
    s_mov_b32 s57, 256
    s_lshl_b32 s58, s22, 2
    s_add_u32 s58, s58, s57
    v_mov_b32 v14, s58
    v_mov_b32 v15, s89
    s_mov_b64 exec, 1
    buffer_store_dword v15, v14, s[28:31], 0 offen sc1
    s_mov_b64 exec, -1
    s_waitcnt vmcnt(1)
    v_mov_b32 v7, 0x3f803f80
    v_dot2_f32_bf16 v64, v16, v7, 0
    v_dot2_f32_bf16 v65, v16, v16, 0
    v_dot2_f32_bf16 v64, v17, v7, v64
    v_dot2_f32_bf16 v65, v17, v17, v65
    v_dot2_f32_bf16 v64, v18, v7, v64
    v_dot2_f32_bf16 v65, v18, v18, v65
    v_dot2_f32_bf16 v64, v19, v7, v64
    v_dot2_f32_bf16 v65, v19, v19, v65
    v_dot2_f32_bf16 v66, v20, v7, 0
    v_dot2_f32_bf16 v67, v20, v20, 0
    v_dot2_f32_bf16 v66, v21, v7, v66
    v_dot2_f32_bf16 v67, v21, v21, v67
    v_dot2_f32_bf16 v66, v22, v7, v66
    v_dot2_f32_bf16 v67, v22, v22, v67
    v_dot2_f32_bf16 v66, v23, v7, v66
    v_dot2_f32_bf16 v67, v23, v23, v67
    v_dot2_f32_bf16 v68, v24, v7, 0
    v_dot2_f32_bf16 v69, v24, v24, 0
    v_dot2_f32_bf16 v68, v25, v7, v68
    v_dot2_f32_bf16 v69, v25, v25, v69
    v_dot2_f32_bf16 v68, v26, v7, v68
    v_dot2_f32_bf16 v69, v26, v26, v69
    v_dot2_f32_bf16 v68, v27, v7, v68
    v_dot2_f32_bf16 v69, v27, v27, v69
    v_add_f32_dpp v64, v64, v64 quad_perm:[1,0,3,2] row_mask:0xf bank_mask:0xf
    v_add_f32_dpp v65, v65, v65 quad_perm:[1,0,3,2] row_mask:0xf bank_mask:0xf
    v_add_f32_dpp v66, v66, v66 quad_perm:[1,0,3,2] row_mask:0xf bank_mask:0xf
    v_add_f32_dpp v67, v67, v67 quad_perm:[1,0,3,2] row_mask:0xf bank_mask:0xf
    v_add_f32_dpp v68, v68, v68 quad_perm:[1,0,3,2] row_mask:0xf bank_mask:0xf
    v_add_f32_dpp v69, v69, v69 quad_perm:[1,0,3,2] row_mask:0xf bank_mask:0xf
    v_add_f32_dpp v64, v64, v64 quad_perm:[2,3,0,1] row_mask:0xf bank_mask:0xf
    v_add_f32_dpp v65, v65, v65 quad_perm:[2,3,0,1] row_mask:0xf bank_mask:0xf
    v_add_f32_dpp v66, v66, v66 quad_perm:[2,3,0,1] row_mask:0xf bank_mask:0xf
    v_add_f32_dpp v67, v67, v67 quad_perm:[2,3,0,1] row_mask:0xf bank_mask:0xf
    v_add_f32_dpp v68, v68, v68 quad_perm:[2,3,0,1] row_mask:0xf bank_mask:0xf
    v_add_f32_dpp v69, v69, v69 quad_perm:[2,3,0,1] row_mask:0xf bank_mask:0xf
    s_mov_b32 s66, 0x22222222
    s_mov_b32 s67, 0x22222222
    v_cndmask_b32 v72, v64, v65, s[66:67]
    v_cndmask_b32 v73, v66, v67, s[66:67]
    v_cndmask_b32 v74, v68, v69, s[66:67]
    v_lshlrev_b32 v12, 9, v9
    v_lshl_add_u32 v12, v8, 4, v12
    v_lshlrev_b32 v13, 2, v9
    v_lshl_add_u32 v13, v8, 4, v13
    s_lshl_b32 s57, s54, 15
    s_lshl_b32 s58, s22, 11
    s_add_u32 s57, s57, s58
    s_add_u32 s57, s57, 196608
    s_add_u32 s59, s58, 98304
    buffer_store_dwordx4 v[16:19], v12, s[28:31], s57 offen offset:0 sc1
    buffer_store_dwordx4 v[20:23], v12, s[28:31], s57 offen offset:256 sc1
    buffer_store_dwordx4 v[24:27], v12, s[28:31], s59 offen offset:256 sc1
    s_lshr_b32 s60, s22, 1
    s_lshl_b32 s60, s60, 9
    s_and_b32 s61, s22, 1
    s_lshl_b32 s61, s61, 3
    s_add_u32 s60, s60, s61
    s_lshl_b32 s57, s54, 12
    s_add_u32 s57, s57, s60
    s_add_u32 s57, s57, 4096
    s_add_u32 s59, s60, 69632
    s_mov_b32 s66, 0x33333333
    s_mov_b32 s67, 0x33333333
    s_mov_b64 exec, s[66:67]
    buffer_store_dword v72, v13, s[28:31], s57 offen offset:0 sc1
    buffer_store_dword v73, v13, s[28:31], s57 offen offset:256 sc1
    buffer_store_dword v74, v13, s[28:31], s59 offen offset:256 sc1
    s_mov_b64 exec, -1
    s_mov_b32 s49, 1
    s_barrier
    s_waitcnt vmcnt(0)
    s_add_u32 s57, s23, s49
    v_mov_b32 v7, s57
    s_lshl_b32 s57, s20, 6
    s_lshl_b32 s58, s22, 2
    s_add_u32 s57, s57, s58
    s_add_u32 s57, s57, 1024
    v_mov_b32 v8, s57
    s_mov_b64 exec, 1
    buffer_store_dword v7, v8, s[28:31], 0 offen sc1
    s_mov_b64 exec, -1
    s_mov_b32 s94, 0
    s_mov_b32 s48, 0
L_layer:
    s_nop 4
    s_waitcnt vmcnt(0) lgkmcnt(0)
    s_mul_i32 s56, s48, 49152
    s_cmp_eq_u32 s48, 0
    s_cbranch_scc0 Lp1v_C_1
    s_lshl_b32 s57, s20, 6
    s_add_u32 s57, s57, 1024
    s_add_u32 s66, s18, s57
    s_addc_u32 s67, s19, 0
    s_add_u32 s68, s23, 1
    s_mov_b32 s69, 0
Lp1s_C_3:
    s_load_dwordx16 s[72:87], s[66:67], 0 glc
    s_add_u32 s69, s69, 1
    s_waitcnt lgkmcnt(0)
    s_xor_b32 s72, s72, s68
    s_xor_b32 s73, s73, s68
    s_xor_b32 s74, s74, s68
    s_xor_b32 s75, s75, s68
    s_xor_b32 s76, s76, s68
    s_xor_b32 s77, s77, s68
    s_xor_b32 s78, s78, s68
    s_xor_b32 s79, s79, s68
    s_xor_b32 s80, s80, s68
    s_xor_b32 s81, s81, s68
    s_xor_b32 s82, s82, s68
    s_xor_b32 s83, s83, s68
    s_xor_b32 s84, s84, s68
    s_xor_b32 s85, s85, s68
    s_xor_b32 s86, s86, s68
    s_xor_b32 s87, s87, s68
    s_or_b32 s72, s72, s80
    s_or_b32 s73, s73, s81
    s_or_b32 s74, s74, s82
    s_or_b32 s75, s75, s83
    s_or_b32 s76, s76, s84
    s_or_b32 s77, s77, s85
    s_or_b32 s78, s78, s86
    s_or_b32 s79, s79, s87
    s_or_b32 s72, s72, s76
    s_or_b32 s73, s73, s77
    s_or_b32 s74, s74, s78
    s_or_b32 s75, s75, s79
    s_or_b32 s72, s72, s74
    s_or_b32 s73, s73, s75
    s_or_b32 s72, s72, s73
    s_cmp_eq_u32 s72, 0
    s_cbranch_scc1 Lp1d_C_2
    s_sleep 2
    s_cmp_lt_u32 s69, 262144
    s_cbranch_scc1 Lp1s_C_3
    s_branch Lp1d_C_2
Lp1v_C_1:
    s_mov_b32 s58, 0x55555555
    s_lshl_b32 s58, s58, s50
    s_cmp_eq_u32 s51, 0
    s_cselect_b32 s64, s58, 0
    s_cselect_b32 s65, 0, s58
    s_add_u32 s68, s23, s49
    s_mov_b32 s69, 0
Lpoll_C_4:
    buffer_load_dword v7, v3, s[28:31], 0 offen sc1
    s_add_u32 s69, s69, 1
    s_waitcnt vmcnt(0)
    v_subrev_u32 v7, s68, v7
    v_cmp_gt_u32 vcc, 16, v7
    s_nop 1
    s_and_b64 s[66:67], vcc, s[64:65]
    s_cmp_eq_u64 s[66:67], s[64:65]
    s_cbranch_scc1 Lpdone_C_5
    s_cmp_lt_u32 s69, 262144
    s_cbranch_scc1 Lpoll_C_4
Lpdone_C_5:
    s_nop 1
    s_cmp_lg_u32 s20, 0
    s_cbranch_scc1 Lp1d_C_2
    s_cmp_eq_u32 s21, 0
    s_cbranch_scc1 Lp1d_C_2
    v_lshlrev_b32 v8, 2, v0
    v_add_u32 v8, 576, v8
    s_mov_b32 s64, 0x0000ffff
    s_mov_b32 s65, 0x00000000
    s_add_u32 s68, s23, 1
    s_mov_b32 s69, 0
Lpoll_C_6:
    buffer_load_dword v7, v8, s[28:31], 0 offen sc1
    s_add_u32 s69, s69, 1
    s_waitcnt vmcnt(0)
    v_subrev_u32 v7, s68, v7
    v_cmp_gt_u32 vcc, 1, v7
    s_nop 1
    s_and_b64 s[66:67], vcc, s[64:65]
    s_cmp_eq_u64 s[66:67], s[64:65]
    s_cbranch_scc1 Lpdone_C_7
    s_cmp_lt_u32 s69, 262144
    s_cbranch_scc1 Lpoll_C_6
Lpdone_C_7:
    s_nop 1
Lp1d_C_2:
    s_nop 1
    s_cmp_eq_u32 s48, 0
    s_mov_b32 s70, 196608
    s_cselect_b32 s70, s70, 196608
    s_mov_b32 s71, 4096
    s_cselect_b32 s71, s71, 4096
    s_mov_b32 s72, 720896
    s_cselect_b32 s72, s72, 720896
    s_mov_b32 s73, 196608
    s_cselect_b32 s73, s73, 196608
    s_mov_b32 s74, 4096
    s_cselect_b32 s74, s74, 4096
    s_mov_b32 s75, 983040
    s_cselect_b32 s75, s75, 983040
    s_lshl_b32 s78, s54, 15
    s_add_u32 s78, s78, s70
    s_lshl_b32 s79, s54, 12
    s_add_u32 s79, s79, s71
    buffer_load_dwordx4 v[128:131], v1, s[28:31], s78 offen offset:0 sc1
    buffer_load_dwordx4 v[132:135], v1, s[28:31], s78 offen offset:1024 sc1
    buffer_load_dwordx4 v[136:139], v1, s[28:31], s78 offen offset:2048 sc1
    buffer_load_dwordx4 v[140:143], v1, s[28:31], s78 offen offset:3072 sc1
    s_add_u32 s78, s78, 4096
    buffer_load_dwordx4 v[144:147], v1, s[28:31], s78 offen offset:0 sc1
    buffer_load_dwordx4 v[148:151], v1, s[28:31], s78 offen offset:1024 sc1
    v_and_b32 v7, 31, v0
    v_lshlrev_b32 v7, 4, v7
    s_barrier
    s_add_u32 s57, s56, 0
    s_and_b32 s57, s57, 0x1ffff
    v_add_u32 v5, s57, v2
    ds_read_b64_tr_b16 v[40:41], v5 offset:0
    ds_read_b64_tr_b16 v[42:43], v5 offset:256
    s_add_u32 s57, s56, 16384
    s_and_b32 s57, s57, 0x1ffff
    v_add_u32 v6, s57, v2
    ds_read_b64_tr_b16 v[44:45], v6 offset:0
    ds_read_b64_tr_b16 v[46:47], v6 offset:256
    ds_read_b64_tr_b16 v[48:49], v5 offset:1024
    ds_read_b64_tr_b16 v[50:51], v5 offset:1280
    ds_read_b64_tr_b16 v[52:53], v6 offset:1024
    ds_read_b64_tr_b16 v[54:55], v6 offset:1280
    ds_read_b64_tr_b16 v[56:57], v5 offset:2048
    ds_read_b64_tr_b16 v[58:59], v5 offset:2304
    s_waitcnt vmcnt(5) lgkmcnt(6)
    v_mfma_f32_32x32x16_bf16 v[64:79], v[40:43], v[128:131], 0
    ds_read_b64_tr_b16 v[60:61], v6 offset:2048
    ds_read_b64_tr_b16 v[62:63], v6 offset:2304
    buffer_load_dwordx4 v[152:155], v1, s[28:31], s78 offen offset:2048 sc1
    v_mfma_f32_32x32x16_bf16 v[80:95], v[44:47], v[128:131], 0
    ds_read_b64_tr_b16 v[40:41], v5 offset:3072
    ds_read_b64_tr_b16 v[42:43], v5 offset:3328
    buffer_load_dwordx4 v[156:159], v1, s[28:31], s78 offen offset:3072 sc1
    s_waitcnt vmcnt(6) lgkmcnt(6)
    v_mfma_f32_32x32x16_bf16 v[64:79], v[48:51], v[132:135], v[64:79]
    ds_read_b64_tr_b16 v[44:45], v6 offset:3072
    ds_read_b64_tr_b16 v[46:47], v6 offset:3328
    s_add_u32 s78, s78, 4096
    buffer_load_dwordx4 v[160:163], v1, s[28:31], s78 offen offset:0 sc1
    v_mfma_f32_32x32x16_bf16 v[80:95], v[52:55], v[132:135], v[80:95]
    ds_read_b64_tr_b16 v[48:49], v5 offset:4096
    ds_read_b64_tr_b16 v[50:51], v5 offset:4352
    buffer_load_dwordx4 v[164:167], v1, s[28:31], s78 offen offset:1024 sc1
    s_waitcnt vmcnt(7) lgkmcnt(6)
    v_mfma_f32_32x32x16_bf16 v[64:79], v[56:59], v[136:139], v[64:79]
    ds_read_b64_tr_b16 v[52:53], v6 offset:4096
    ds_read_b64_tr_b16 v[54:55], v6 offset:4352
    buffer_load_dwordx4 v[168:171], v1, s[28:31], s78 offen offset:2048 sc1
    v_mfma_f32_32x32x16_bf16 v[80:95], v[60:63], v[136:139], v[80:95]
    ds_read_b64_tr_b16 v[56:57], v5 offset:5120
    ds_read_b64_tr_b16 v[58:59], v5 offset:5376
    buffer_load_dwordx4 v[172:175], v1, s[28:31], s78 offen offset:3072 sc1
    s_waitcnt vmcnt(8) lgkmcnt(6)
    v_mfma_f32_32x32x16_bf16 v[64:79], v[40:43], v[140:143], v[64:79]
    ds_read_b64_tr_b16 v[60:61], v6 offset:5120
    ds_read_b64_tr_b16 v[62:63], v6 offset:5376
    buffer_load_dwordx4 v[96:99], v7, s[28:31], s79 offen offset:0 sc1
    v_mfma_f32_32x32x16_bf16 v[80:95], v[44:47], v[140:143], v[80:95]
    ds_read_b64_tr_b16 v[40:41], v5 offset:6144
    ds_read_b64_tr_b16 v[42:43], v5 offset:6400
    buffer_load_dwordx4 v[100:103], v7, s[28:31], s79 offen offset:512 sc1
    s_waitcnt vmcnt(9) lgkmcnt(6)
    v_mfma_f32_32x32x16_bf16 v[64:79], v[48:51], v[144:147], v[64:79]
    ds_read_b64_tr_b16 v[44:45], v6 offset:6144
    ds_read_b64_tr_b16 v[46:47], v6 offset:6400
    buffer_load_dwordx4 v[104:107], v7, s[28:31], s79 offen offset:1024 sc1
    v_mfma_f32_32x32x16_bf16 v[80:95], v[52:55], v[144:147], v[80:95]
    ds_read_b64_tr_b16 v[48:49], v5 offset:7168
    ds_read_b64_tr_b16 v[50:51], v5 offset:7424
    buffer_load_dwordx4 v[108:111], v7, s[28:31], s79 offen offset:1536 sc1
    s_waitcnt vmcnt(10) lgkmcnt(6)
    v_mfma_f32_32x32x16_bf16 v[64:79], v[56:59], v[148:151], v[64:79]
    ds_read_b64_tr_b16 v[52:53], v6 offset:7168
    ds_read_b64_tr_b16 v[54:55], v6 offset:7424
    buffer_load_dwordx4 v[112:115], v7, s[28:31], s79 offen offset:2048 sc1
    v_mfma_f32_32x32x16_bf16 v[80:95], v[60:63], v[148:151], v[80:95]
    ds_read_b64_tr_b16 v[56:57], v5 offset:8192
    ds_read_b64_tr_b16 v[58:59], v5 offset:8448
    buffer_load_dwordx4 v[116:119], v7, s[28:31], s79 offen offset:2560 sc1
    s_waitcnt vmcnt(11) lgkmcnt(6)
    v_mfma_f32_32x32x16_bf16 v[64:79], v[40:43], v[152:155], v[64:79]
    ds_read_b64_tr_b16 v[60:61], v6 offset:8192
    ds_read_b64_tr_b16 v[62:63], v6 offset:8448
    buffer_load_dwordx4 v[120:123], v7, s[28:31], s79 offen offset:3072 sc1
    v_mfma_f32_32x32x16_bf16 v[80:95], v[44:47], v[152:155], v[80:95]
    ds_read_b64_tr_b16 v[40:41], v5 offset:9216
    ds_read_b64_tr_b16 v[42:43], v5 offset:9472
    buffer_load_dwordx4 v[124:127], v7, s[28:31], s79 offen offset:3584 sc1
    s_waitcnt vmcnt(12) lgkmcnt(6)
    v_mfma_f32_32x32x16_bf16 v[64:79], v[48:51], v[156:159], v[64:79]
    ds_read_b64_tr_b16 v[44:45], v6 offset:9216
    ds_read_b64_tr_b16 v[46:47], v6 offset:9472
    s_add_u32 s78, s78, 4096
    buffer_load_dwordx4 v[176:179], v1, s[28:31], s78 offen offset:0 sc1
    v_mfma_f32_32x32x16_bf16 v[80:95], v[52:55], v[156:159], v[80:95]
    ds_read_b64_tr_b16 v[48:49], v5 offset:10240
    ds_read_b64_tr_b16 v[50:51], v5 offset:10496
    buffer_load_dwordx4 v[180:183], v1, s[28:31], s78 offen offset:1024 sc1
    s_waitcnt vmcnt(13) lgkmcnt(6)
    v_mfma_f32_32x32x16_bf16 v[64:79], v[56:59], v[160:163], v[64:79]
    ds_read_b64_tr_b16 v[52:53], v6 offset:10240
    ds_read_b64_tr_b16 v[54:55], v6 offset:10496
    buffer_load_dwordx4 v[184:187], v1, s[28:31], s78 offen offset:2048 sc1
    v_mfma_f32_32x32x16_bf16 v[80:95], v[60:63], v[160:163], v[80:95]
    ds_read_b64_tr_b16 v[56:57], v5 offset:11264
    ds_read_b64_tr_b16 v[58:59], v5 offset:11520
    buffer_load_dwordx4 v[188:191], v1, s[28:31], s78 offen offset:3072 sc1
    s_waitcnt vmcnt(14) lgkmcnt(6)
    v_mfma_f32_32x32x16_bf16 v[64:79], v[40:43], v[164:167], v[64:79]
    ds_read_b64_tr_b16 v[60:61], v6 offset:11264
    ds_read_b64_tr_b16 v[62:63], v6 offset:11520
    s_add_u32 s78, s78, 4096
    buffer_load_dwordx4 v[192:195], v1, s[28:31], s78 offen offset:0 sc1
    v_mfma_f32_32x32x16_bf16 v[80:95], v[44:47], v[164:167], v[80:95]
    ds_read_b64_tr_b16 v[40:41], v5 offset:12288
    ds_read_b64_tr_b16 v[42:43], v5 offset:12544
    buffer_load_dwordx4 v[196:199], v1, s[28:31], s78 offen offset:1024 sc1
    s_waitcnt vmcnt(15) lgkmcnt(6)
    v_mfma_f32_32x32x16_bf16 v[64:79], v[48:51], v[168:171], v[64:79]
    ds_read_b64_tr_b16 v[44:45], v6 offset:12288
    ds_read_b64_tr_b16 v[46:47], v6 offset:12544
    buffer_load_dwordx4 v[200:203], v1, s[28:31], s78 offen offset:2048 sc1
    s_barrier
    v_mfma_f32_32x32x16_bf16 v[80:95], v[52:55], v[168:171], v[80:95]
    ds_read_b64_tr_b16 v[48:49], v5 offset:13312
    ds_read_b64_tr_b16 v[50:51], v5 offset:13568
    buffer_load_dwordx4 v[204:207], v1, s[28:31], s78 offen offset:3072 sc1
    s_waitcnt vmcnt(16) lgkmcnt(6)
    v_mfma_f32_32x32x16_bf16 v[64:79], v[56:59], v[172:175], v[64:79]
    ds_read_b64_tr_b16 v[52:53], v6 offset:13312
    ds_read_b64_tr_b16 v[54:55], v6 offset:13568
    s_add_u32 s78, s78, 4096
    buffer_load_dwordx4 v[208:211], v1, s[28:31], s78 offen offset:0 sc1
    v_mfma_f32_32x32x16_bf16 v[80:95], v[60:63], v[172:175], v[80:95]
    ds_read_b64_tr_b16 v[56:57], v5 offset:14336
    ds_read_b64_tr_b16 v[58:59], v5 offset:14592
    buffer_load_dwordx4 v[212:215], v1, s[28:31], s78 offen offset:1024 sc1
    s_waitcnt vmcnt(9) lgkmcnt(6)
    v_mfma_f32_32x32x16_bf16 v[64:79], v[40:43], v[176:179], v[64:79]
    ds_read_b64_tr_b16 v[60:61], v6 offset:14336
    ds_read_b64_tr_b16 v[62:63], v6 offset:14592
    buffer_load_dwordx4 v[216:219], v1, s[28:31], s78 offen offset:2048 sc1
    v_mfma_f32_32x32x16_bf16 v[80:95], v[44:47], v[176:179], v[80:95]
    ds_read_b64_tr_b16 v[40:41], v5 offset:15360
    ds_read_b64_tr_b16 v[42:43], v5 offset:15616
    buffer_load_dwordx4 v[220:223], v1, s[28:31], s78 offen offset:3072 sc1
    s_waitcnt vmcnt(10) lgkmcnt(6)
    v_mfma_f32_32x32x16_bf16 v[64:79], v[48:51], v[180:183], v[64:79]
    ds_read_b64_tr_b16 v[44:45], v6 offset:15360
    ds_read_b64_tr_b16 v[46:47], v6 offset:15616
    s_add_u32 s78, s78, 4096
    buffer_load_dwordx4 v[224:227], v1, s[28:31], s78 offen offset:0 sc1
    v_mfma_f32_32x32x16_bf16 v[80:95], v[52:55], v[180:183], v[80:95]
    s_add_u32 s57, s56, 32768
    s_and_b32 s57, s57, 0x1ffff
    v_add_u32 v5, s57, v2
    ds_read_b64_tr_b16 v[48:49], v5 offset:0
    ds_read_b64_tr_b16 v[50:51], v5 offset:256
    buffer_load_dwordx4 v[228:231], v1, s[28:31], s78 offen offset:1024 sc1
    s_waitcnt vmcnt(11) lgkmcnt(6)
    v_mfma_f32_32x32x16_bf16 v[64:79], v[56:59], v[184:187], v[64:79]
    s_add_u32 s57, s56, 49152
    s_and_b32 s57, s57, 0x1ffff
    v_add_u32 v6, s57, v2
    ds_read_b64_tr_b16 v[52:53], v6 offset:0
    ds_read_b64_tr_b16 v[54:55], v6 offset:256
    buffer_load_dwordx4 v[232:235], v1, s[28:31], s78 offen offset:2048 sc1
    v_mfma_f32_32x32x16_bf16 v[80:95], v[60:63], v[184:187], v[80:95]
    ds_read_b64_tr_b16 v[56:57], v5 offset:1024
    ds_read_b64_tr_b16 v[58:59], v5 offset:1280
    buffer_load_dwordx4 v[236:239], v1, s[28:31], s78 offen offset:3072 sc1
    s_waitcnt vmcnt(12) lgkmcnt(6)
    v_mfma_f32_32x32x16_bf16 v[64:79], v[40:43], v[188:191], v[64:79]
    ds_read_b64_tr_b16 v[60:61], v6 offset:1024
    ds_read_b64_tr_b16 v[62:63], v6 offset:1280
    s_add_u32 s78, s78, 4096
    buffer_load_dwordx4 v[240:243], v1, s[28:31], s78 offen offset:0 sc1
    v_add_f32 v96, v96, v98
    v_mfma_f32_32x32x16_bf16 v[80:95], v[44:47], v[188:191], v[80:95]
    ds_read_b64_tr_b16 v[40:41], v5 offset:2048
    ds_read_b64_tr_b16 v[42:43], v5 offset:2304
    buffer_load_dwordx4 v[244:247], v1, s[28:31], s78 offen offset:1024 sc1
    v_add_f32 v100, v100, v102
    v_add_f32 v104, v104, v106
    s_waitcnt vmcnt(13) lgkmcnt(6)
    v_mfma_f32_32x32x16_bf16 v[64:79], v[48:51], v[192:195], v[64:79]
    ds_read_b64_tr_b16 v[44:45], v6 offset:2048
    ds_read_b64_tr_b16 v[46:47], v6 offset:2304
    buffer_load_dwordx4 v[248:251], v1, s[28:31], s78 offen offset:2048 sc1
    v_add_f32 v108, v108, v110
    v_add_f32 v112, v112, v114
    v_mfma_f32_32x32x16_bf16 v[80:95], v[52:55], v[192:195], v[80:95]
    ds_read_b64_tr_b16 v[48:49], v5 offset:3072
    ds_read_b64_tr_b16 v[50:51], v5 offset:3328
    buffer_load_dwordx4 v[252:255], v1, s[28:31], s78 offen offset:3072 sc1
    v_add_f32 v116, v116, v118
    v_add_f32 v120, v120, v122
    s_waitcnt vmcnt(14) lgkmcnt(6)
    v_mfma_f32_32x32x16_bf16 v[64:79], v[56:59], v[196:199], v[64:79]
    ds_read_b64_tr_b16 v[52:53], v6 offset:3072
    ds_read_b64_tr_b16 v[54:55], v6 offset:3328
    v_add_f32 v124, v124, v126
    v_add_f32 v96, v96, v100
    v_add_f32 v104, v104, v108
    v_mfma_f32_32x32x16_bf16 v[80:95], v[60:63], v[196:199], v[80:95]
    ds_read_b64_tr_b16 v[56:57], v5 offset:4096
    ds_read_b64_tr_b16 v[58:59], v5 offset:4352
    v_add_f32 v112, v112, v116
    v_add_f32 v120, v120, v124
    v_add_f32 v96, v96, v104
    s_waitcnt vmcnt(13) lgkmcnt(6)
    v_mfma_f32_32x32x16_bf16 v[64:79], v[40:43], v[200:203], v[64:79]
    ds_read_b64_tr_b16 v[60:61], v6 offset:4096
    ds_read_b64_tr_b16 v[62:63], v6 offset:4352
    v_add_f32 v112, v112, v120
    v_add_f32 v96, v96, v112
    v_add_f32 v97, v97, v99
    v_mfma_f32_32x32x16_bf16 v[80:95], v[44:47], v[200:203], v[80:95]
    ds_read_b64_tr_b16 v[40:41], v5 offset:5120
    ds_read_b64_tr_b16 v[42:43], v5 offset:5376
    v_add_f32 v101, v101, v103
    v_add_f32 v105, v105, v107
    v_add_f32 v109, v109, v111
    s_waitcnt vmcnt(12) lgkmcnt(6)
    v_mfma_f32_32x32x16_bf16 v[64:79], v[48:51], v[204:207], v[64:79]
    ds_read_b64_tr_b16 v[44:45], v6 offset:5120
    ds_read_b64_tr_b16 v[46:47], v6 offset:5376
    v_add_f32 v113, v113, v115
    v_add_f32 v117, v117, v119
    v_add_f32 v121, v121, v123
    v_mfma_f32_32x32x16_bf16 v[80:95], v[52:55], v[204:207], v[80:95]
    ds_read_b64_tr_b16 v[48:49], v5 offset:6144
    ds_read_b64_tr_b16 v[50:51], v5 offset:6400
    v_add_f32 v125, v125, v127
    v_add_f32 v97, v97, v101
    v_add_f32 v105, v105, v109
    s_waitcnt vmcnt(11) lgkmcnt(6)
    v_mfma_f32_32x32x16_bf16 v[64:79], v[56:59], v[208:211], v[64:79]
    ds_read_b64_tr_b16 v[52:53], v6 offset:6144
    ds_read_b64_tr_b16 v[54:55], v6 offset:6400
    v_add_f32 v113, v113, v117
    v_add_f32 v121, v121, v125
    v_add_f32 v97, v97, v105
    v_mfma_f32_32x32x16_bf16 v[80:95], v[60:63], v[208:211], v[80:95]
    ds_read_b64_tr_b16 v[56:57], v5 offset:7168
    ds_read_b64_tr_b16 v[58:59], v5 offset:7424
    v_add_f32 v113, v113, v121
    v_add_f32 v97, v97, v113
    v_mul_f32 v8, 0x3b000000, v96
    s_waitcnt vmcnt(10) lgkmcnt(6)
    v_mfma_f32_32x32x16_bf16 v[64:79], v[40:43], v[212:215], v[64:79]
    ds_read_b64_tr_b16 v[60:61], v6 offset:7168
    ds_read_b64_tr_b16 v[62:63], v6 offset:7424
    v_mul_f32 v9, 0x3b000000, v97
    v_fma_f32 v9, -v8, v8, v9
    v_max_f32 v9, 0, v9
    v_mfma_f32_32x32x16_bf16 v[80:95], v[44:47], v[212:215], v[80:95]
    ds_read_b64_tr_b16 v[40:41], v5 offset:8192
    ds_read_b64_tr_b16 v[42:43], v5 offset:8448
    v_cvt_pk_bf16_f32 v10, v8, v8
    v_cvt_pk_bf16_f32 v9, v9, v9
    v_xor_b32 v28, 0x80008000, v10
    s_waitcnt vmcnt(9) lgkmcnt(6)
    v_mfma_f32_32x32x16_bf16 v[64:79], v[48:51], v[216:219], v[64:79]
    ds_read_b64_tr_b16 v[44:45], v6 offset:8192
    ds_read_b64_tr_b16 v[46:47], v6 offset:8448
    v_and_b32 v9, 0xffff0000, v9
    v_and_b32 v29, 0xffff, v28
    v_add_f32 v9, 0x3727c5ac, v9
    v_mfma_f32_32x32x16_bf16 v[80:95], v[52:55], v[216:219], v[80:95]
    ds_read_b64_tr_b16 v[48:49], v5 offset:9216
    ds_read_b64_tr_b16 v[50:51], v5 offset:9472
    v_cvt_pk_bf16_f32 v9, v9, v9
    v_and_b32 v9, 0xffff0000, v9
    s_waitcnt vmcnt(8) lgkmcnt(6)
    v_mfma_f32_32x32x16_bf16 v[64:79], v[56:59], v[220:223], v[64:79]
    ds_read_b64_tr_b16 v[52:53], v6 offset:9216
    ds_read_b64_tr_b16 v[54:55], v6 offset:9472
    v_sqrt_f32 v9, v9
    s_nop 0
    v_cvt_pk_bf16_f32 v9, v9, v9
    v_mfma_f32_32x32x16_bf16 v[80:95], v[60:63], v[220:223], v[80:95]
    ds_read_b64_tr_b16 v[56:57], v5 offset:10240
    ds_read_b64_tr_b16 v[58:59], v5 offset:10496
    v_and_b32 v9, 0xffff0000, v9
    v_rcp_f32 v12, v9
    s_waitcnt vmcnt(7) lgkmcnt(6)
    v_mfma_f32_32x32x16_bf16 v[64:79], v[40:43], v[224:227], v[64:79]
    ds_read_b64_tr_b16 v[60:61], v6 offset:10240
    ds_read_b64_tr_b16 v[62:63], v6 offset:10496
    v_mfma_f32_32x32x16_bf16 v[80:95], v[44:47], v[224:227], v[80:95]
    ds_read_b64_tr_b16 v[40:41], v5 offset:11264
    ds_read_b64_tr_b16 v[42:43], v5 offset:11520
    s_waitcnt vmcnt(6) lgkmcnt(6)
    v_mfma_f32_32x32x16_bf16 v[64:79], v[48:51], v[228:231], v[64:79]
    ds_read_b64_tr_b16 v[44:45], v6 offset:11264
    ds_read_b64_tr_b16 v[46:47], v6 offset:11520
    v_mfma_f32_32x32x16_bf16 v[80:95], v[52:55], v[228:231], v[80:95]
    ds_read_b64_tr_b16 v[48:49], v5 offset:12288
    ds_read_b64_tr_b16 v[50:51], v5 offset:12544
    s_waitcnt vmcnt(5) lgkmcnt(6)
    v_mfma_f32_32x32x16_bf16 v[64:79], v[56:59], v[232:235], v[64:79]
    ds_read_b64_tr_b16 v[52:53], v6 offset:12288
    ds_read_b64_tr_b16 v[54:55], v6 offset:12544
    v_mfma_f32_32x32x16_bf16 v[80:95], v[60:63], v[232:235], v[80:95]
    ds_read_b64_tr_b16 v[56:57], v5 offset:13312
    ds_read_b64_tr_b16 v[58:59], v5 offset:13568
    s_waitcnt vmcnt(4) lgkmcnt(6)
    v_mfma_f32_32x32x16_bf16 v[64:79], v[40:43], v[236:239], v[64:79]
    ds_read_b64_tr_b16 v[60:61], v6 offset:13312
    ds_read_b64_tr_b16 v[62:63], v6 offset:13568
    v_mfma_f32_32x32x16_bf16 v[80:95], v[44:47], v[236:239], v[80:95]
    ds_read_b64_tr_b16 v[40:41], v5 offset:14336
    ds_read_b64_tr_b16 v[42:43], v5 offset:14592
    s_waitcnt vmcnt(3) lgkmcnt(6)
    v_mfma_f32_32x32x16_bf16 v[64:79], v[48:51], v[240:243], v[64:79]
    ds_read_b64_tr_b16 v[44:45], v6 offset:14336
    ds_read_b64_tr_b16 v[46:47], v6 offset:14592
    v_mfma_f32_32x32x16_bf16 v[80:95], v[52:55], v[240:243], v[80:95]
    ds_read_b64_tr_b16 v[48:49], v5 offset:15360
    ds_read_b64_tr_b16 v[50:51], v5 offset:15616
    s_waitcnt vmcnt(2) lgkmcnt(6)
    v_mfma_f32_32x32x16_bf16 v[64:79], v[56:59], v[244:247], v[64:79]
    ds_read_b64_tr_b16 v[52:53], v6 offset:15360
    ds_read_b64_tr_b16 v[54:55], v6 offset:15616
    v_mfma_f32_32x32x16_bf16 v[80:95], v[60:63], v[244:247], v[80:95]
    s_add_u32 s57, s56, 65536
    s_and_b32 s57, s57, 0x1ffff
    v_add_u32 v5, s57, v2
    ds_read_b64_tr_b16 v[56:57], v5 offset:0
    ds_read_b64_tr_b16 v[58:59], v5 offset:256
    s_waitcnt vmcnt(1) lgkmcnt(6)
    v_mfma_f32_32x32x16_bf16 v[64:79], v[40:43], v[248:251], v[64:79]
    ds_read_b64_tr_b16 v[60:61], v5 offset:1024
    ds_read_b64_tr_b16 v[62:63], v5 offset:1280
    v_mfma_f32_32x32x16_bf16 v[80:95], v[44:47], v[248:251], v[80:95]
    ds_read_b64_tr_b16 v[40:41], v5 offset:2048
    ds_read_b64_tr_b16 v[42:43], v5 offset:2304
    s_waitcnt vmcnt(0) lgkmcnt(6)
    v_mfma_f32_32x32x16_bf16 v[64:79], v[48:51], v[252:255], v[64:79]
    ds_read_b64_tr_b16 v[44:45], v5 offset:3072
    ds_read_b64_tr_b16 v[46:47], v5 offset:3328
    v_mfma_f32_32x32x16_bf16 v[80:95], v[52:55], v[252:255], v[80:95]
    s_barrier
    v_lshlrev_b32 v13, 3, v0
    v_add_u32 v13, 158720, v13
    ds_read_b64 v[32:33], v13 offset:0
    ds_read_b64 v[36:37], v13 offset:512
    s_mov_b32 s57, 256
    v_lshlrev_b32 v27, 2, v0
    v_add_u32 v27, s57, v27
    buffer_load_dword v127, v27, s[28:31], 0 offen sc1
    s_waitcnt lgkmcnt(6)
    v_mfma_f32_32x32x16_bf16 v[96:111], v[56:59], v[128:131], 0
    v_mfma_f32_32x32x16_bf16 v[96:111], v[60:63], v[132:135], v[96:111]
    ds_read_b64_tr_b16 v[48:49], v5 offset:4096
    ds_read_b64_tr_b16 v[50:51], v5 offset:4352
    s_waitcnt lgkmcnt(4)
    v_mfma_f32_32x32x16_bf16 v[96:111], v[40:43], v[136:139], v[96:111]
    ds_read_b64_tr_b16 v[52:53], v5 offset:5120
    ds_read_b64_tr_b16 v[54:55], v5 offset:5376
    v_mfma_f32_32x32x16_bf16 v[96:111], v[44:47], v[140:143], v[96:111]
    ds_read_b64_tr_b16 v[56:57], v5 offset:6144
    ds_read_b64_tr_b16 v[58:59], v5 offset:6400
    s_waitcnt lgkmcnt(7)
    v_mfma_f32_32x32x16_bf16 v[64:79], v[32:35], v[28:31], v[64:79]
    ds_read_b64_tr_b16 v[60:61], v5 offset:7168
    ds_read_b64_tr_b16 v[62:63], v5 offset:7424
    s_waitcnt lgkmcnt(8)
    v_mfma_f32_32x32x16_bf16 v[80:95], v[36:39], v[28:31], v[80:95]
    ds_read_b64_tr_b16 v[40:41], v5 offset:8192
    ds_read_b64_tr_b16 v[42:43], v5 offset:8448
    ds_read_b64 v[32:33], v13 offset:1024
    s_waitcnt lgkmcnt(7)
    v_mfma_f32_32x32x16_bf16 v[96:111], v[48:51], v[144:147], v[96:111]
    ds_read_b64_tr_b16 v[44:45], v5 offset:9216
    ds_read_b64_tr_b16 v[46:47], v5 offset:9472
    v_mfma_f32_32x32x16_bf16 v[96:111], v[52:55], v[148:151], v[96:111]
    ds_read_b64_tr_b16 v[48:49], v5 offset:10240
    ds_read_b64_tr_b16 v[50:51], v5 offset:10496
    s_waitcnt lgkmcnt(7)
    v_mfma_f32_32x32x16_bf16 v[96:111], v[56:59], v[152:155], v[96:111]
    ds_read_b64_tr_b16 v[52:53], v5 offset:11264
    ds_read_b64_tr_b16 v[54:55], v5 offset:11520
    v_mfma_f32_32x32x16_bf16 v[96:111], v[60:63], v[156:159], v[96:111]
    ds_read_b64_tr_b16 v[56:57], v5 offset:12288
    ds_read_b64_tr_b16 v[58:59], v5 offset:12544
    v_mul_f32 v64, v64, v12
    v_mul_f32 v65, v65, v12
    v_mul_f32 v66, v66, v12
    s_waitcnt lgkmcnt(6)
    v_mfma_f32_32x32x16_bf16 v[96:111], v[40:43], v[160:163], v[96:111]
    ds_read_b64_tr_b16 v[60:61], v5 offset:13312
    ds_read_b64_tr_b16 v[62:63], v5 offset:13568
    v_mul_f32 v67, v67, v12
    v_mul_f32 v68, v68, v12
    v_mul_f32 v69, v69, v12
    v_mfma_f32_32x32x16_bf16 v[96:111], v[44:47], v[164:167], v[96:111]
    ds_read_b64_tr_b16 v[40:41], v5 offset:14336
    ds_read_b64_tr_b16 v[42:43], v5 offset:14592
    v_mul_f32 v70, v70, v12
    v_mul_f32 v71, v71, v12
    v_cvt_pk_bf16_f32 v16, v64, v65
    s_waitcnt lgkmcnt(6)
    v_mfma_f32_32x32x16_bf16 v[96:111], v[48:51], v[168:171], v[96:111]
    ds_read_b64_tr_b16 v[44:45], v5 offset:15360
    ds_read_b64_tr_b16 v[46:47], v5 offset:15616
    v_cvt_pk_bf16_f32 v17, v66, v67
    v_cvt_pk_bf16_f32 v18, v68, v69
    v_cvt_pk_bf16_f32 v19, v70, v71
    v_mfma_f32_32x32x16_bf16 v[96:111], v[52:55], v[172:175], v[96:111]
    s_add_u32 s57, s56, 81920
    s_and_b32 s57, s57, 0x1ffff
    v_add_u32 v5, s57, v2
    ds_read_b64_tr_b16 v[48:49], v5 offset:0
    ds_read_b64_tr_b16 v[50:51], v5 offset:256
    v_mul_f32 v72, v72, v12
    v_mul_f32 v73, v73, v12
    v_mul_f32 v74, v74, v12
    s_waitcnt lgkmcnt(6)
    v_mfma_f32_32x32x16_bf16 v[96:111], v[56:59], v[176:179], v[96:111]
    ds_read_b64_tr_b16 v[52:53], v5 offset:1024
    ds_read_b64_tr_b16 v[54:55], v5 offset:1280
    v_mul_f32 v75, v75, v12
    v_mul_f32 v76, v76, v12
    v_mul_f32 v77, v77, v12
    v_mfma_f32_32x32x16_bf16 v[96:111], v[60:63], v[180:183], v[96:111]
    ds_read_b64_tr_b16 v[56:57], v5 offset:2048
    ds_read_b64_tr_b16 v[58:59], v5 offset:2304
    v_mul_f32 v78, v78, v12
    v_mul_f32 v79, v79, v12
    v_cvt_pk_bf16_f32 v20, v72, v73
    s_waitcnt lgkmcnt(6)
    v_mfma_f32_32x32x16_bf16 v[96:111], v[40:43], v[184:187], v[96:111]
    ds_read_b64_tr_b16 v[60:61], v5 offset:3072
    ds_read_b64_tr_b16 v[62:63], v5 offset:3328
    v_cvt_pk_bf16_f32 v21, v74, v75
    v_cvt_pk_bf16_f32 v22, v76, v77
    v_cvt_pk_bf16_f32 v23, v78, v79
    v_mfma_f32_32x32x16_bf16 v[96:111], v[44:47], v[188:191], v[96:111]
    ds_read_b64_tr_b16 v[40:41], v5 offset:4096
    ds_read_b64_tr_b16 v[42:43], v5 offset:4352
    v_and_b32 v14, 31, v0
    s_lshl_b32 s57, s20, 5
    s_add_u32 s57, s57, 16
    v_add_u32 v14, s57, v14
    v_lshlrev_b32 v14, 4, v14
    v_add_u32 v14, 131072, v14
    v_lshrrev_b32 v15, 5, v0
    v_mul_u32_u24 v15, 2304, v15
    v_add_u32 v24, v14, v15
    v_add_u32 v25, v24, v15
    s_waitcnt lgkmcnt(6)
    v_mfma_f32_32x32x16_bf16 v[96:111], v[48:51], v[192:195], v[96:111]
    ds_read_b64_tr_b16 v[44:45], v5 offset:5120
    ds_read_b64_tr_b16 v[46:47], v5 offset:5376
    ds_write_b128 v24, v[16:19] offset:0
    ds_write_b128 v24, v[20:23] offset:4608
    v_mul_f32 v80, v80, v12
    v_mfma_f32_32x32x16_bf16 v[96:111], v[52:55], v[196:199], v[96:111]
    ds_read_b64_tr_b16 v[48:49], v5 offset:6144
    ds_read_b64_tr_b16 v[50:51], v5 offset:6400
    v_mul_f32 v81, v81, v12
    v_mul_f32 v82, v82, v12
    v_mul_f32 v83, v83, v12
    s_waitcnt lgkmcnt(8)
    v_mfma_f32_32x32x16_bf16 v[96:111], v[56:59], v[200:203], v[96:111]
    ds_read_b64_tr_b16 v[52:53], v5 offset:7168
    ds_read_b64_tr_b16 v[54:55], v5 offset:7424
    ds_write_b128 v25, v[80:83] offset:9216
    v_mul_f32 v84, v84, v12
    v_mul_f32 v85, v85, v12
    v_mfma_f32_32x32x16_bf16 v[96:111], v[60:63], v[204:207], v[96:111]
    ds_read_b64_tr_b16 v[56:57], v5 offset:8192
    ds_read_b64_tr_b16 v[58:59], v5 offset:8448
    v_mul_f32 v86, v86, v12
    v_mul_f32 v87, v87, v12
    ds_write_b128 v25, v[84:87] offset:11520
    s_waitcnt lgkmcnt(10)
    v_mfma_f32_32x32x16_bf16 v[96:111], v[40:43], v[208:211], v[96:111]
    ds_read_b64_tr_b16 v[60:61], v5 offset:9216
    ds_read_b64_tr_b16 v[62:63], v5 offset:9472
    v_mul_f32 v88, v88, v12
    v_mul_f32 v89, v89, v12
    v_mul_f32 v90, v90, v12
    v_mfma_f32_32x32x16_bf16 v[96:111], v[44:47], v[212:215], v[96:111]
    ds_read_b64_tr_b16 v[40:41], v5 offset:10240
    ds_read_b64_tr_b16 v[42:43], v5 offset:10496
    v_mul_f32 v91, v91, v12
    ds_write_b128 v25, v[88:91] offset:18432
    v_mul_f32 v92, v92, v12
    s_waitcnt lgkmcnt(9)
    v_mfma_f32_32x32x16_bf16 v[96:111], v[48:51], v[216:219], v[96:111]
    ds_read_b64_tr_b16 v[44:45], v5 offset:11264
    ds_read_b64_tr_b16 v[46:47], v5 offset:11520
    v_mul_f32 v93, v93, v12
    v_mul_f32 v94, v94, v12
    v_mul_f32 v95, v95, v12
    v_mfma_f32_32x32x16_bf16 v[96:111], v[52:55], v[220:223], v[96:111]
    ds_read_b64_tr_b16 v[48:49], v5 offset:12288
    ds_read_b64_tr_b16 v[50:51], v5 offset:12544
    ds_write_b128 v25, v[92:95] offset:20736
    s_waitcnt lgkmcnt(8)
    v_mfma_f32_32x32x16_bf16 v[96:111], v[56:59], v[224:227], v[96:111]
    ds_read_b64_tr_b16 v[52:53], v5 offset:13312
    ds_read_b64_tr_b16 v[54:55], v5 offset:13568
    v_mfma_f32_32x32x16_bf16 v[96:111], v[60:63], v[228:231], v[96:111]
    ds_read_b64_tr_b16 v[56:57], v5 offset:14336
    ds_read_b64_tr_b16 v[58:59], v5 offset:14592
    s_waitcnt lgkmcnt(7)
    v_mfma_f32_32x32x16_bf16 v[96:111], v[40:43], v[232:235], v[96:111]
    ds_read_b64_tr_b16 v[60:61], v5 offset:15360
    ds_read_b64_tr_b16 v[62:63], v5 offset:15616
    v_mfma_f32_32x32x16_bf16 v[96:111], v[44:47], v[236:239], v[96:111]
    s_waitcnt lgkmcnt(4)
    v_mfma_f32_32x32x16_bf16 v[96:111], v[48:51], v[240:243], v[96:111]
    v_mfma_f32_32x32x16_bf16 v[96:111], v[52:55], v[244:247], v[96:111]
    s_waitcnt lgkmcnt(0)
    v_mfma_f32_32x32x16_bf16 v[96:111], v[56:59], v[248:251], v[96:111]
    v_mfma_f32_32x32x16_bf16 v[96:111], v[60:63], v[252:255], v[96:111]
    v_mfma_f32_32x32x16_bf16 v[96:111], v[32:35], v[28:31], v[96:111]
    s_nop 11
    v_mul_f32 v96, v96, v12
    v_mul_f32 v97, v97, v12
    v_mul_f32 v98, v98, v12
    v_mul_f32 v99, v99, v12
    v_mul_f32 v100, v100, v12
    v_mul_f32 v101, v101, v12
    v_mul_f32 v102, v102, v12
    v_mul_f32 v103, v103, v12
    v_mul_f32 v104, v104, v12
    v_mul_f32 v105, v105, v12
    v_mul_f32 v106, v106, v12
    v_mul_f32 v107, v107, v12
    v_mul_f32 v108, v108, v12
    v_mul_f32 v109, v109, v12
    v_mul_f32 v110, v110, v12
    v_mul_f32 v111, v111, v12
    v_cvt_pk_bf16_f32 v112, v96, v97
    v_cvt_pk_bf16_f32 v113, v98, v99
    v_cvt_pk_bf16_f32 v114, v100, v101
    v_cvt_pk_bf16_f32 v115, v102, v103
    v_cvt_pk_bf16_f32 v116, v104, v105
    v_cvt_pk_bf16_f32 v117, v106, v107
    v_cvt_pk_bf16_f32 v118, v108, v109
    v_cvt_pk_bf16_f32 v119, v110, v111
    s_waitcnt vmcnt(0)
    s_mov_b32 s64, 0x0000ffff
    s_mov_b32 s65, 0x00000000
    s_add_u32 s68, s23, 16
    v_subrev_u32 v126, s68, v127
    v_cmp_gt_u32 vcc, 8, v126
    s_nop 1
    s_and_b64 s[66:67], vcc, s[64:65]
    s_cmp_eq_u64 s[66:67], s[64:65]
    s_cbranch_scc1 Lidok_C_8
    s_mov_b32 s69, 0
Lpoll_C_10:
    buffer_load_dword v126, v27, s[28:31], 0 offen sc1
    s_add_u32 s69, s69, 1
    s_waitcnt vmcnt(0)
    v_subrev_u32 v126, s68, v126
    v_cmp_gt_u32 vcc, 8, v126
    s_nop 1
    s_and_b64 s[66:67], vcc, s[64:65]
    s_cmp_eq_u64 s[66:67], s[64:65]
    s_cbranch_scc1 Lpdone_C_11
    s_cmp_lt_u32 s69, 262144
    s_cbranch_scc1 Lpoll_C_10
Lpdone_C_11:
    s_nop 1
Lidok_C_8:
    s_sub_u32 s57, s89, s68
    v_cmp_eq_u32 vcc, s57, v126
    s_nop 1
    s_and_b64 s[66:67], vcc, s[64:65]
    s_cmp_eq_u64 s[66:67], s[64:65]
    s_cselect_b32 s34, 4194304, 0
    s_cselect_b32 s38, 0, 4194304
    v_mov_b32 v126, s34
    v_mov_b32 v125, 163360
    ds_write_b32 v125, v126
    s_waitcnt lgkmcnt(0)
    s_barrier
    v_subrev_u32 v24, 224, v24
    v_subrev_u32 v25, 224, v25
    ds_read_b128 v[128:131], v24 offset:224
    ds_read_b128 v[132:135], v24 offset:192
    ds_read_b128 v[136:139], v24 offset:160
    ds_read_b128 v[140:143], v24 offset:128
    ds_read_b128 v[144:147], v24 offset:96
    ds_read_b128 v[148:151], v24 offset:64
    ds_read_b128 v[152:155], v24 offset:32
    ds_read_b128 v[156:159], v24 offset:0
    ds_read_b128 v[160:163], v24 offset:4832
    ds_read_b128 v[164:167], v24 offset:4800
    ds_read_b128 v[168:171], v24 offset:4768
    ds_read_b128 v[172:175], v24 offset:4736
    ds_read_b128 v[176:179], v24 offset:4704
    ds_read_b128 v[180:183], v24 offset:4672
    ds_read_b128 v[184:187], v24 offset:4640
    s_waitcnt lgkmcnt(14)
    ds_read_b128 v[188:191], v24 offset:4608
    s_waitcnt lgkmcnt(8)
    v_dot2_f32_bf16 v192, v112, v128, 0
    v_dot2_f32_bf16 v193, v112, v132, 0
    v_dot2_f32_bf16 v194, v112, v136, 0
    v_dot2_f32_bf16 v195, v112, v140, 0
    v_dot2_f32_bf16 v196, v112, v144, 0
    v_dot2_f32_bf16 v197, v112, v148, 0
    v_dot2_f32_bf16 v198, v112, v152, 0
    v_dot2_f32_bf16 v199, v112, v156, 0
    v_dot2_f32_bf16 v192, v113, v129, v192
    v_dot2_f32_bf16 v193, v113, v133, v193
    v_dot2_f32_bf16 v194, v113, v137, v194
    v_dot2_f32_bf16 v195, v113, v141, v195
    v_dot2_f32_bf16 v196, v113, v145, v196
    v_dot2_f32_bf16 v197, v113, v149, v197
    v_dot2_f32_bf16 v198, v113, v153, v198
    v_dot2_f32_bf16 v199, v113, v157, v199
    v_dot2_f32_bf16 v192, v114, v130, v192
    v_dot2_f32_bf16 v193, v114, v134, v193
    v_dot2_f32_bf16 v194, v114, v138, v194
    v_dot2_f32_bf16 v195, v114, v142, v195
    v_dot2_f32_bf16 v196, v114, v146, v196
    v_dot2_f32_bf16 v197, v114, v150, v197
    v_dot2_f32_bf16 v198, v114, v154, v198
    v_dot2_f32_bf16 v199, v114, v158, v199
    v_dot2_f32_bf16 v192, v115, v131, v192
    v_dot2_f32_bf16 v193, v115, v135, v193
    v_dot2_f32_bf16 v194, v115, v139, v194
    v_dot2_f32_bf16 v195, v115, v143, v195
    v_dot2_f32_bf16 v196, v115, v147, v196
    v_dot2_f32_bf16 v197, v115, v151, v197
    v_dot2_f32_bf16 v198, v115, v155, v198
    v_dot2_f32_bf16 v199, v115, v159, v199
    s_waitcnt lgkmcnt(0)
    v_dot2_f32_bf16 v200, v116, v160, 0
    v_dot2_f32_bf16 v201, v116, v164, 0
    v_dot2_f32_bf16 v202, v116, v168, 0
    v_dot2_f32_bf16 v203, v116, v172, 0
    v_dot2_f32_bf16 v204, v116, v176, 0
    v_dot2_f32_bf16 v205, v116, v180, 0
    v_dot2_f32_bf16 v206, v116, v184, 0
    v_dot2_f32_bf16 v207, v116, v188, 0
    v_dot2_f32_bf16 v200, v117, v161, v200
    v_dot2_f32_bf16 v201, v117, v165, v201
    v_dot2_f32_bf16 v202, v117, v169, v202
    v_dot2_f32_bf16 v203, v117, v173, v203
    v_dot2_f32_bf16 v204, v117, v177, v204
    v_dot2_f32_bf16 v205, v117, v181, v205
    v_dot2_f32_bf16 v206, v117, v185, v206
    v_dot2_f32_bf16 v207, v117, v189, v207
    v_dot2_f32_bf16 v200, v118, v162, v200
    v_dot2_f32_bf16 v201, v118, v166, v201
    v_dot2_f32_bf16 v202, v118, v170, v202
    v_dot2_f32_bf16 v203, v118, v174, v203
    v_dot2_f32_bf16 v204, v118, v178, v204
    v_dot2_f32_bf16 v205, v118, v182, v205
    v_dot2_f32_bf16 v206, v118, v186, v206
    v_dot2_f32_bf16 v207, v118, v190, v207
    v_dot2_f32_bf16 v200, v119, v163, v200
    v_dot2_f32_bf16 v201, v119, v167, v201
    v_dot2_f32_bf16 v202, v119, v171, v202
    v_dot2_f32_bf16 v203, v119, v175, v203
    v_dot2_f32_bf16 v204, v119, v179, v204
    v_dot2_f32_bf16 v205, v119, v183, v205
    v_dot2_f32_bf16 v206, v119, v187, v206
    v_dot2_f32_bf16 v207, v119, v191, v207
    ds_read_b128 v[208:211], v25 offset:9440
    ds_read_b128 v[212:215], v25 offset:11744
    ds_read_b128 v[216:219], v25 offset:9408
    ds_read_b128 v[220:223], v25 offset:11712
    ds_read_b128 v[224:227], v25 offset:9376
    ds_read_b128 v[228:231], v25 offset:11680
    ds_read_b128 v[232:235], v25 offset:9344
    ds_read_b128 v[236:239], v25 offset:11648
    ds_read_b128 v[240:243], v25 offset:9312
    ds_read_b128 v[244:247], v25 offset:11616
    ds_read_b128 v[248:251], v25 offset:9280
    ds_read_b128 v[252:255], v25 offset:11584
    ds_read_b128 v[64:67], v25 offset:9248
    ds_read_b128 v[68:71], v25 offset:11552
    v_permlane32_swap_b32 v192, v200
    v_permlane32_swap_b32 v193, v201
    v_permlane32_swap_b32 v194, v202
    v_permlane32_swap_b32 v195, v203
    v_permlane32_swap_b32 v196, v204
    v_permlane32_swap_b32 v197, v205
    v_permlane32_swap_b32 v198, v206
    v_permlane32_swap_b32 v199, v207
    v_add_f32 v192, v192, v200
    v_add_f32 v193, v193, v201
    v_add_f32 v194, v194, v202
    v_add_f32 v195, v195, v203
    v_add_f32 v196, v196, v204
    v_add_f32 v197, v197, v205
    v_add_f32 v198, v198, v206
    v_add_f32 v199, v199, v207
    s_lshl_b32 s57, s21, 2
    s_add_u32 s57, s57, s20
    s_cmp_lg_u32 s57, 0
    s_cbranch_scc1 Lnomask_C_12
    v_and_b32 v7, 31, v0
    v_mov_b32 v26, 0xcf6e6b28
    v_cmp_gt_u32 vcc, 2, v7
    s_nop 1
    v_cndmask_b32 v193, v193, v26, vcc
    v_cmp_gt_u32 vcc, 4, v7
    s_nop 1
    v_cndmask_b32 v194, v194, v26, vcc
    v_cmp_gt_u32 vcc, 6, v7
    s_nop 1
    v_cndmask_b32 v195, v195, v26, vcc
    v_cmp_gt_u32 vcc, 8, v7
    s_nop 1
    v_cndmask_b32 v196, v196, v26, vcc
    v_cmp_gt_u32 vcc, 10, v7
    s_nop 1
    v_cndmask_b32 v197, v197, v26, vcc
    v_cmp_gt_u32 vcc, 12, v7
    s_nop 1
    v_cndmask_b32 v198, v198, v26, vcc
    v_cmp_gt_u32 vcc, 14, v7
    s_nop 1
    v_cndmask_b32 v199, v199, v26, vcc
Lnomask_C_12:
    s_nop 1
    v_max3_f32 v26, v192, v193, v194
    v_max3_f32 v27, v195, v196, v197
    v_max3_f32 v26, v26, v198, v199
    v_max_f32 v26, v26, v27
    s_mov_b32 s57, 0x3eb8aa3b
    v_mul_f32 v26, 0xbeb8aa3b, v26
    v_fma_f32 v192, v192, s57, v26
    v_fma_f32 v193, v193, s57, v26
    v_fma_f32 v194, v194, s57, v26
    v_fma_f32 v195, v195, s57, v26
    v_fma_f32 v196, v196, s57, v26
    v_fma_f32 v197, v197, s57, v26
    v_fma_f32 v198, v198, s57, v26
    v_fma_f32 v199, v199, s57, v26
    v_exp_f32 v192, v192
    v_exp_f32 v193, v193
    v_exp_f32 v194, v194
    v_exp_f32 v195, v195
    v_exp_f32 v196, v196
    v_exp_f32 v197, v197
    v_exp_f32 v198, v198
    v_exp_f32 v199, v199
    s_waitcnt lgkmcnt(12)
    ds_read_b128 v[72:75], v25 offset:9216
    ds_read_b128 v[76:79], v25 offset:11520
    v_add_f32 v26, v192, v193
    v_add_f32 v27, v194, v195
    v_add_f32 v15, v196, v197
    v_add_f32 v14, v198, v199
    v_add_f32 v26, v26, v27
    v_add_f32 v15, v15, v14
    v_add_f32 v26, v26, v15
    v_rcp_f32 v26, v26
    s_nop 0
    v_mul_f32 v192, v192, v26
    v_mul_f32 v193, v193, v26
    v_mul_f32 v194, v194, v26
    v_mul_f32 v195, v195, v26
    v_mul_f32 v196, v196, v26
    v_mul_f32 v197, v197, v26
    v_mul_f32 v198, v198, v26
    v_mul_f32 v199, v199, v26
    v_mov_b32 v200, v192
    v_mov_b32 v201, v193
    v_mov_b32 v202, v194
    v_mov_b32 v203, v195
    v_mov_b32 v204, v196
    v_mov_b32 v205, v197
    v_mov_b32 v206, v198
    v_mov_b32 v207, v199
    v_permlane32_swap_b32 v192, v200
    v_permlane32_swap_b32 v193, v201
    v_permlane32_swap_b32 v194, v202
    v_permlane32_swap_b32 v195, v203
    v_permlane32_swap_b32 v196, v204
    v_permlane32_swap_b32 v197, v205
    v_permlane32_swap_b32 v198, v206
    v_permlane32_swap_b32 v199, v207
    v_pk_mul_f32 v[96:97], v[208:209], v[192:193] op_sel:[0,0] op_sel_hi:[1,0]
    v_pk_mul_f32 v[98:99], v[210:211], v[192:193] op_sel:[0,0] op_sel_hi:[1,0]
    v_pk_mul_f32 v[100:101], v[212:213], v[192:193] op_sel:[0,0] op_sel_hi:[1,0]
    v_pk_mul_f32 v[102:103], v[214:215], v[192:193] op_sel:[0,0] op_sel_hi:[1,0]
    s_waitcnt lgkmcnt(13)
    v_pk_fma_f32 v[96:97], v[216:217], v[192:193], v[96:97] op_sel:[0,1,0] op_sel_hi:[1,1,1]
    v_pk_fma_f32 v[98:99], v[218:219], v[192:193], v[98:99] op_sel:[0,1,0] op_sel_hi:[1,1,1]
    ds_read_b128 v[128:131], v25 offset:18656
    s_waitcnt lgkmcnt(13)
    v_pk_fma_f32 v[100:101], v[220:221], v[192:193], v[100:101] op_sel:[0,1,0] op_sel_hi:[1,1,1]
    v_pk_fma_f32 v[102:103], v[222:223], v[192:193], v[102:103] op_sel:[0,1,0] op_sel_hi:[1,1,1]
    ds_read_b128 v[132:135], v25 offset:20960
    s_waitcnt lgkmcnt(13)
    v_pk_fma_f32 v[96:97], v[224:225], v[194:195], v[96:97] op_sel:[0,0,0] op_sel_hi:[1,0,1]
    v_pk_fma_f32 v[98:99], v[226:227], v[194:195], v[98:99] op_sel:[0,0,0] op_sel_hi:[1,0,1]
    ds_read_b128 v[136:139], v25 offset:18624
    s_waitcnt lgkmcnt(13)
    v_pk_fma_f32 v[100:101], v[228:229], v[194:195], v[100:101] op_sel:[0,0,0] op_sel_hi:[1,0,1]
    v_pk_fma_f32 v[102:103], v[230:231], v[194:195], v[102:103] op_sel:[0,0,0] op_sel_hi:[1,0,1]
    ds_read_b128 v[140:143], v25 offset:20928
    s_waitcnt lgkmcnt(13)
    v_pk_fma_f32 v[96:97], v[232:233], v[194:195], v[96:97] op_sel:[0,1,0] op_sel_hi:[1,1,1]
    v_pk_fma_f32 v[98:99], v[234:235], v[194:195], v[98:99] op_sel:[0,1,0] op_sel_hi:[1,1,1]
    ds_read_b128 v[144:147], v25 offset:18592
    s_waitcnt lgkmcnt(13)
    v_pk_fma_f32 v[100:101], v[236:237], v[194:195], v[100:101] op_sel:[0,1,0] op_sel_hi:[1,1,1]
    v_pk_fma_f32 v[102:103], v[238:239], v[194:195], v[102:103] op_sel:[0,1,0] op_sel_hi:[1,1,1]
    ds_read_b128 v[148:151], v25 offset:20896
    s_waitcnt lgkmcnt(13)
    v_pk_fma_f32 v[96:97], v[240:241], v[196:197], v[96:97] op_sel:[0,0,0] op_sel_hi:[1,0,1]
    v_pk_fma_f32 v[98:99], v[242:243], v[196:197], v[98:99] op_sel:[0,0,0] op_sel_hi:[1,0,1]
    ds_read_b128 v[152:155], v25 offset:18560
    s_waitcnt lgkmcnt(13)
    v_pk_fma_f32 v[100:101], v[244:245], v[196:197], v[100:101] op_sel:[0,0,0] op_sel_hi:[1,0,1]
    v_pk_fma_f32 v[102:103], v[246:247], v[196:197], v[102:103] op_sel:[0,0,0] op_sel_hi:[1,0,1]
    ds_read_b128 v[156:159], v25 offset:20864
    s_waitcnt lgkmcnt(13)
    v_pk_fma_f32 v[96:97], v[248:249], v[196:197], v[96:97] op_sel:[0,1,0] op_sel_hi:[1,1,1]
    v_pk_fma_f32 v[98:99], v[250:251], v[196:197], v[98:99] op_sel:[0,1,0] op_sel_hi:[1,1,1]
    ds_read_b128 v[160:163], v25 offset:18528
    s_waitcnt lgkmcnt(13)
    v_pk_fma_f32 v[100:101], v[252:253], v[196:197], v[100:101] op_sel:[0,1,0] op_sel_hi:[1,1,1]
    v_pk_fma_f32 v[102:103], v[254:255], v[196:197], v[102:103] op_sel:[0,1,0] op_sel_hi:[1,1,1]
    ds_read_b128 v[164:167], v25 offset:20832
    s_waitcnt lgkmcnt(13)
    v_pk_fma_f32 v[96:97], v[64:65], v[198:199], v[96:97] op_sel:[0,0,0] op_sel_hi:[1,0,1]
    v_pk_fma_f32 v[98:99], v[66:67], v[198:199], v[98:99] op_sel:[0,0,0] op_sel_hi:[1,0,1]
    ds_read_b128 v[168:171], v25 offset:18496
    s_waitcnt lgkmcnt(13)
    v_pk_fma_f32 v[100:101], v[68:69], v[198:199], v[100:101] op_sel:[0,0,0] op_sel_hi:[1,0,1]
    v_pk_fma_f32 v[102:103], v[70:71], v[198:199], v[102:103] op_sel:[0,0,0] op_sel_hi:[1,0,1]
    ds_read_b128 v[172:175], v25 offset:20800
    s_waitcnt lgkmcnt(13)
    v_pk_fma_f32 v[96:97], v[72:73], v[198:199], v[96:97] op_sel:[0,1,0] op_sel_hi:[1,1,1]
    v_pk_fma_f32 v[98:99], v[74:75], v[198:199], v[98:99] op_sel:[0,1,0] op_sel_hi:[1,1,1]
    ds_read_b128 v[176:179], v25 offset:18464
    s_waitcnt lgkmcnt(13)
    v_pk_fma_f32 v[100:101], v[76:77], v[198:199], v[100:101] op_sel:[0,1,0] op_sel_hi:[1,1,1]
    v_pk_fma_f32 v[102:103], v[78:79], v[198:199], v[102:103] op_sel:[0,1,0] op_sel_hi:[1,1,1]
    ds_read_b128 v[180:183], v25 offset:20768
    ds_read_b128 v[184:187], v25 offset:18432
    s_waitcnt lgkmcnt(14)
    ds_read_b128 v[188:191], v25 offset:20736
    v_pk_mul_f32 v[104:105], v[128:129], v[200:201] op_sel:[0,0] op_sel_hi:[1,0]
    v_pk_mul_f32 v[106:107], v[130:131], v[200:201] op_sel:[0,0] op_sel_hi:[1,0]
    s_waitcnt lgkmcnt(14)
    v_pk_mul_f32 v[108:109], v[132:133], v[200:201] op_sel:[0,0] op_sel_hi:[1,0]
    v_pk_mul_f32 v[110:111], v[134:135], v[200:201] op_sel:[0,0] op_sel_hi:[1,0]
    s_waitcnt lgkmcnt(13)
    v_pk_fma_f32 v[104:105], v[136:137], v[200:201], v[104:105] op_sel:[0,1,0] op_sel_hi:[1,1,1]
    v_pk_fma_f32 v[106:107], v[138:139], v[200:201], v[106:107] op_sel:[0,1,0] op_sel_hi:[1,1,1]
    s_waitcnt lgkmcnt(12)
    v_pk_fma_f32 v[108:109], v[140:141], v[200:201], v[108:109] op_sel:[0,1,0] op_sel_hi:[1,1,1]
    v_pk_fma_f32 v[110:111], v[142:143], v[200:201], v[110:111] op_sel:[0,1,0] op_sel_hi:[1,1,1]
    s_waitcnt lgkmcnt(11)
    v_pk_fma_f32 v[104:105], v[144:145], v[202:203], v[104:105] op_sel:[0,0,0] op_sel_hi:[1,0,1]
    v_pk_fma_f32 v[106:107], v[146:147], v[202:203], v[106:107] op_sel:[0,0,0] op_sel_hi:[1,0,1]
    s_waitcnt lgkmcnt(10)
    v_pk_fma_f32 v[108:109], v[148:149], v[202:203], v[108:109] op_sel:[0,0,0] op_sel_hi:[1,0,1]
    v_pk_fma_f32 v[110:111], v[150:151], v[202:203], v[110:111] op_sel:[0,0,0] op_sel_hi:[1,0,1]
    s_waitcnt lgkmcnt(9)
    v_pk_fma_f32 v[104:105], v[152:153], v[202:203], v[104:105] op_sel:[0,1,0] op_sel_hi:[1,1,1]
    v_pk_fma_f32 v[106:107], v[154:155], v[202:203], v[106:107] op_sel:[0,1,0] op_sel_hi:[1,1,1]
    s_waitcnt lgkmcnt(8)
    v_pk_fma_f32 v[108:109], v[156:157], v[202:203], v[108:109] op_sel:[0,1,0] op_sel_hi:[1,1,1]
    v_pk_fma_f32 v[110:111], v[158:159], v[202:203], v[110:111] op_sel:[0,1,0] op_sel_hi:[1,1,1]
    s_waitcnt lgkmcnt(7)
    v_pk_fma_f32 v[104:105], v[160:161], v[204:205], v[104:105] op_sel:[0,0,0] op_sel_hi:[1,0,1]
    v_pk_fma_f32 v[106:107], v[162:163], v[204:205], v[106:107] op_sel:[0,0,0] op_sel_hi:[1,0,1]
    s_waitcnt lgkmcnt(6)
    v_pk_fma_f32 v[108:109], v[164:165], v[204:205], v[108:109] op_sel:[0,0,0] op_sel_hi:[1,0,1]
    v_pk_fma_f32 v[110:111], v[166:167], v[204:205], v[110:111] op_sel:[0,0,0] op_sel_hi:[1,0,1]
    s_waitcnt lgkmcnt(5)
    v_pk_fma_f32 v[104:105], v[168:169], v[204:205], v[104:105] op_sel:[0,1,0] op_sel_hi:[1,1,1]
    v_pk_fma_f32 v[106:107], v[170:171], v[204:205], v[106:107] op_sel:[0,1,0] op_sel_hi:[1,1,1]
    s_waitcnt lgkmcnt(4)
    v_pk_fma_f32 v[108:109], v[172:173], v[204:205], v[108:109] op_sel:[0,1,0] op_sel_hi:[1,1,1]
    v_pk_fma_f32 v[110:111], v[174:175], v[204:205], v[110:111] op_sel:[0,1,0] op_sel_hi:[1,1,1]
    s_waitcnt lgkmcnt(3)
    v_pk_fma_f32 v[104:105], v[176:177], v[206:207], v[104:105] op_sel:[0,0,0] op_sel_hi:[1,0,1]
    v_pk_fma_f32 v[106:107], v[178:179], v[206:207], v[106:107] op_sel:[0,0,0] op_sel_hi:[1,0,1]
    s_waitcnt lgkmcnt(2)
    v_pk_fma_f32 v[108:109], v[180:181], v[206:207], v[108:109] op_sel:[0,0,0] op_sel_hi:[1,0,1]
    v_pk_fma_f32 v[110:111], v[182:183], v[206:207], v[110:111] op_sel:[0,0,0] op_sel_hi:[1,0,1]
    s_waitcnt lgkmcnt(1)
    v_pk_fma_f32 v[104:105], v[184:185], v[206:207], v[104:105] op_sel:[0,1,0] op_sel_hi:[1,1,1]
    v_pk_fma_f32 v[106:107], v[186:187], v[206:207], v[106:107] op_sel:[0,1,0] op_sel_hi:[1,1,1]
    s_waitcnt lgkmcnt(0)
    v_pk_fma_f32 v[108:109], v[188:189], v[206:207], v[108:109] op_sel:[0,1,0] op_sel_hi:[1,1,1]
    v_pk_fma_f32 v[110:111], v[190:191], v[206:207], v[110:111] op_sel:[0,1,0] op_sel_hi:[1,1,1]
    v_cvt_pk_bf16_f32 v16, v96, v97
    v_cvt_pk_bf16_f32 v17, v98, v99
    v_cvt_pk_bf16_f32 v18, v100, v101
    v_cvt_pk_bf16_f32 v19, v102, v103
    v_cvt_pk_bf16_f32 v20, v104, v105
    v_cvt_pk_bf16_f32 v21, v106, v107
    v_cvt_pk_bf16_f32 v22, v108, v109
    v_cvt_pk_bf16_f32 v23, v110, v111
    v_permlane32_swap_b32 v16, v18
    v_permlane32_swap_b32 v17, v19
    v_permlane32_swap_b32 v20, v22
    v_permlane32_swap_b32 v21, v23
    s_lshl_b32 s57, s54, 15
    s_lshl_b32 s58, s22, 11
    s_add_u32 s57, s57, s58
    s_add_u32 s57, s57, s72
    buffer_store_dwordx4 v[16:19], v1, s[32:35], s57 offen offset:0
    buffer_store_dwordx4 v[16:19], v1, s[36:39], s57 offen offset:0 sc1
    buffer_store_dwordx4 v[20:23], v1, s[32:35], s57 offen offset:1024
    buffer_store_dwordx4 v[20:23], v1, s[36:39], s57 offen offset:1024 sc1
    s_add_u32 s49, s49, 1
    s_waitcnt vmcnt(0)
    s_add_u32 s57, s23, s49
    v_mov_b32 v7, s57
    s_mov_b64 exec, 1
    buffer_store_dword v7, v4, s[32:35], 0 offen
    buffer_store_dword v7, v4, s[36:39], 0 offen sc1
    s_mov_b64 exec, -1
    s_lshl_b32 s82, s51, 15
    s_lshl_b32 s83, s51, 14
    v_lshrrev_b32 v12, 5, v0
    v_lshlrev_b32 v12, 10, v12
    v_bfe_u32 v13, v0, 2, 2
    v_lshl_add_u32 v12, v13, 7, v12
    v_bfe_u32 v13, v0, 3, 1
    v_lshl_add_u32 v12, v13, 6, v12
    v_bfe_u32 v13, v0, 4, 1
    v_lshl_add_u32 v12, v13, 5, v12
    v_and_b32 v13, 3, v0
    v_lshl_add_u32 v12, v13, 3, v12
    s_lshl_b32 s57, s51, 6
    v_xor_b32 v12, s57, v12
    v_xor_b32 v13, 64, v12
    v_and_b32 v7, 31, v0
    v_lshlrev_b32 v7, 4, v7
    v_lshrrev_b32 v8, 5, v0
    v_lshl_add_u32 v7, v8, 3, v7
    s_lshl_b32 s57, s55, 15
    s_lshl_b32 s58, s53, 12
    s_add_u32 s57, s57, s58
    s_lshl_b32 s58, s51, 11
    s_add_u32 s80, s57, s58
    s_add_u32 s57, s80, s70
    s_cmp_eq_u32 s48, 0
    s_cbranch_scc1 Lresx_C_13
    buffer_load_dwordx2 v[16:17], v7, s[28:31], s57 offen offset:0 sc1
    buffer_load_dwordx2 v[18:19], v7, s[28:31], s57 offen offset:512 sc1
    buffer_load_dwordx2 v[20:21], v7, s[28:31], s57 offen offset:1024 sc1
    buffer_load_dwordx2 v[22:23], v7, s[28:31], s57 offen offset:1536 sc1
    s_branch Lresd_C_14
Lresx_C_13:
    v_and_b32 v9, 31, v0
    s_lshl_b32 s57, s98, 5
    v_add_u32 v9, s57, v9
    v_lshlrev_b32 v9, 10, v9
    v_lshl_add_u32 v9, v8, 3, v9
    s_lshl_b32 s57, s53, 7
    s_lshl_b32 s58, s51, 6
    s_add_u32 s57, s57, s58
    buffer_load_dwordx2 v[16:17], v9, s[40:43], s57 offen offset:0
    buffer_load_dwordx2 v[18:19], v9, s[40:43], s57 offen offset:16
    buffer_load_dwordx2 v[20:21], v9, s[40:43], s57 offen offset:32
    buffer_load_dwordx2 v[22:23], v9, s[40:43], s57 offen offset:48
Lresd_C_14:
    s_waitcnt vmcnt(0)
    v_lshlrev_b32 v64, 16, v16
    v_and_b32 v65, 0xffff0000, v16
    v_lshlrev_b32 v66, 16, v17
    v_and_b32 v67, 0xffff0000, v17
    v_lshlrev_b32 v68, 16, v18
    v_and_b32 v69, 0xffff0000, v18
    v_lshlrev_b32 v70, 16, v19
    v_and_b32 v71, 0xffff0000, v19
    v_lshlrev_b32 v72, 16, v20
    v_and_b32 v73, 0xffff0000, v20
    v_lshlrev_b32 v74, 16, v21
    v_and_b32 v75, 0xffff0000, v21
    v_lshlrev_b32 v76, 16, v22
    v_and_b32 v77, 0xffff0000, v22
    v_lshlrev_b32 v78, 16, v23
    v_and_b32 v79, 0xffff0000, v23
    s_lshl_b32 s57, s52, 1
    s_add_u32 s57, s57, s50
    s_mov_b32 s58, 0x11111111
    s_lshl_b32 s58, s58, s57
    s_cmp_eq_u32 s51, 0
    s_cselect_b32 s64, s58, 0
    s_cselect_b32 s65, 0, s58
    s_add_u32 s68, s23, s49
    s_mov_b32 s69, 0
Lpoll_C_15:
    buffer_load_dword v7, v3, s[28:31], 0 offen sc1
    s_add_u32 s69, s69, 1
    s_waitcnt vmcnt(0)
    v_subrev_u32 v7, s68, v7
    v_cmp_gt_u32 vcc, 16, v7
    s_nop 1
    s_and_b64 s[66:67], vcc, s[64:65]
    s_cmp_eq_u64 s[66:67], s[64:65]
    s_cbranch_scc1 Lpdone_C_16
    s_cmp_lt_u32 s69, 262144
    s_cbranch_scc1 Lpoll_C_15
Lpdone_C_16:
    s_nop 1
    s_mul_i32 s78, s55, 32768
    s_add_u32 s78, s78, s72
    s_mul_i32 s57, s51, 16384
    s_add_u32 s78, s78, s57
    buffer_load_dwordx4 v[128:131], v1, s[28:31], s78 offen offset:0 sc1
    buffer_load_dwordx4 v[132:135], v1, s[28:31], s78 offen offset:1024 sc1
    buffer_load_dwordx4 v[136:139], v1, s[28:31], s78 offen offset:2048 sc1
    buffer_load_dwordx4 v[140:143], v1, s[28:31], s78 offen offset:3072 sc1
    s_add_u32 s78, s78, 4096
    buffer_load_dwordx4 v[144:147], v1, s[28:31], s78 offen offset:0 sc1
    buffer_load_dwordx4 v[148:151], v1, s[28:31], s78 offen offset:1024 sc1
    s_barrier
    s_add_u32 s57, s56, 98304
    s_add_u32 s57, s57, s82
    s_and_b32 s57, s57, 0x1ffff
    v_add_u32 v5, s57, v12
    ds_read_b64_tr_b16 v[40:41], v5 offset:0
    ds_read_b64_tr_b16 v[42:43], v5 offset:512
    s_add_u32 s57, s56, 98304
    s_add_u32 s57, s57, s82
    s_and_b32 s57, s57, 0x1ffff
    v_add_u32 v6, s57, v13
    ds_read_b64_tr_b16 v[44:45], v6 offset:0
    ds_read_b64_tr_b16 v[46:47], v6 offset:512
    ds_read_b64_tr_b16 v[48:49], v5 offset:2048
    ds_read_b64_tr_b16 v[50:51], v5 offset:2560
    ds_read_b64_tr_b16 v[52:53], v6 offset:2048
    ds_read_b64_tr_b16 v[54:55], v6 offset:2560
    ds_read_b64_tr_b16 v[56:57], v5 offset:4096
    ds_read_b64_tr_b16 v[58:59], v5 offset:4608
    s_waitcnt vmcnt(5) lgkmcnt(6)
    v_mfma_f32_32x32x16_bf16 v[64:79], v[40:43], v[128:131], v[64:79]
    ds_read_b64_tr_b16 v[60:61], v6 offset:4096
    ds_read_b64_tr_b16 v[62:63], v6 offset:4608
    buffer_load_dwordx4 v[152:155], v1, s[28:31], s78 offen offset:2048 sc1
    v_mfma_f32_32x32x16_bf16 v[80:95], v[44:47], v[128:131], 0
    ds_read_b64_tr_b16 v[40:41], v5 offset:6144
    ds_read_b64_tr_b16 v[42:43], v5 offset:6656
    buffer_load_dwordx4 v[156:159], v1, s[28:31], s78 offen offset:3072 sc1
    s_waitcnt vmcnt(6) lgkmcnt(6)
    v_mfma_f32_32x32x16_bf16 v[64:79], v[48:51], v[132:135], v[64:79]
    ds_read_b64_tr_b16 v[44:45], v6 offset:6144
    ds_read_b64_tr_b16 v[46:47], v6 offset:6656
    s_add_u32 s78, s78, 4096
    buffer_load_dwordx4 v[160:163], v1, s[28:31], s78 offen offset:0 sc1
    v_mfma_f32_32x32x16_bf16 v[80:95], v[52:55], v[132:135], v[80:95]
    ds_read_b64_tr_b16 v[48:49], v5 offset:8192
    ds_read_b64_tr_b16 v[50:51], v5 offset:8704
    buffer_load_dwordx4 v[164:167], v1, s[28:31], s78 offen offset:1024 sc1
    s_waitcnt vmcnt(7) lgkmcnt(6)
    v_mfma_f32_32x32x16_bf16 v[64:79], v[56:59], v[136:139], v[64:79]
    ds_read_b64_tr_b16 v[52:53], v6 offset:8192
    ds_read_b64_tr_b16 v[54:55], v6 offset:8704
    buffer_load_dwordx4 v[168:171], v1, s[28:31], s78 offen offset:2048 sc1
    v_mfma_f32_32x32x16_bf16 v[80:95], v[60:63], v[136:139], v[80:95]
    ds_read_b64_tr_b16 v[56:57], v5 offset:10240
    ds_read_b64_tr_b16 v[58:59], v5 offset:10752
    buffer_load_dwordx4 v[172:175], v1, s[28:31], s78 offen offset:3072 sc1
    s_waitcnt vmcnt(8) lgkmcnt(6)
    v_mfma_f32_32x32x16_bf16 v[64:79], v[40:43], v[140:143], v[64:79]
    ds_read_b64_tr_b16 v[60:61], v6 offset:10240
    ds_read_b64_tr_b16 v[62:63], v6 offset:10752
    s_add_u32 s78, s78, 4096
    buffer_load_dwordx4 v[176:179], v1, s[28:31], s78 offen offset:0 sc1
    v_mfma_f32_32x32x16_bf16 v[80:95], v[44:47], v[140:143], v[80:95]
    ds_read_b64_tr_b16 v[40:41], v5 offset:12288
    ds_read_b64_tr_b16 v[42:43], v5 offset:12800
    buffer_load_dwordx4 v[180:183], v1, s[28:31], s78 offen offset:1024 sc1
    s_waitcnt vmcnt(9) lgkmcnt(6)
    v_mfma_f32_32x32x16_bf16 v[64:79], v[48:51], v[144:147], v[64:79]
    ds_read_b64_tr_b16 v[44:45], v6 offset:12288
    ds_read_b64_tr_b16 v[46:47], v6 offset:12800
    buffer_load_dwordx4 v[184:187], v1, s[28:31], s78 offen offset:2048 sc1
    v_mfma_f32_32x32x16_bf16 v[80:95], v[52:55], v[144:147], v[80:95]
    ds_read_b64_tr_b16 v[48:49], v5 offset:14336
    ds_read_b64_tr_b16 v[50:51], v5 offset:14848
    buffer_load_dwordx4 v[188:191], v1, s[28:31], s78 offen offset:3072 sc1
    s_waitcnt vmcnt(10) lgkmcnt(6)
    v_mfma_f32_32x32x16_bf16 v[64:79], v[56:59], v[148:151], v[64:79]
    ds_read_b64_tr_b16 v[52:53], v6 offset:14336
    ds_read_b64_tr_b16 v[54:55], v6 offset:14848
    v_mfma_f32_32x32x16_bf16 v[80:95], v[60:63], v[148:151], v[80:95]
    s_add_u32 s57, s56, 114688
    s_add_u32 s57, s57, s82
    s_and_b32 s57, s57, 0x1ffff
    v_add_u32 v5, s57, v12
    ds_read_b64_tr_b16 v[56:57], v5 offset:0
    ds_read_b64_tr_b16 v[58:59], v5 offset:512
    s_barrier
    s_waitcnt vmcnt(9) lgkmcnt(6)
    v_mfma_f32_32x32x16_bf16 v[64:79], v[40:43], v[152:155], v[64:79]
    s_add_u32 s57, s56, 114688
    s_add_u32 s57, s57, s82
    s_and_b32 s57, s57, 0x1ffff
    v_add_u32 v6, s57, v13
    ds_read_b64_tr_b16 v[60:61], v6 offset:0
    ds_read_b64_tr_b16 v[62:63], v6 offset:512
    v_mfma_f32_32x32x16_bf16 v[80:95], v[44:47], v[152:155], v[80:95]
    ds_read_b64_tr_b16 v[40:41], v5 offset:2048
    ds_read_b64_tr_b16 v[42:43], v5 offset:2560
    s_waitcnt vmcnt(8) lgkmcnt(6)
    v_mfma_f32_32x32x16_bf16 v[64:79], v[48:51], v[156:159], v[64:79]
    ds_read_b64_tr_b16 v[44:45], v6 offset:2048
    ds_read_b64_tr_b16 v[46:47], v6 offset:2560
    v_mfma_f32_32x32x16_bf16 v[80:95], v[52:55], v[156:159], v[80:95]
    ds_read_b64_tr_b16 v[48:49], v5 offset:4096
    ds_read_b64_tr_b16 v[50:51], v5 offset:4608
    s_waitcnt vmcnt(7) lgkmcnt(6)
    v_mfma_f32_32x32x16_bf16 v[64:79], v[56:59], v[160:163], v[64:79]
    ds_read_b64_tr_b16 v[52:53], v6 offset:4096
    ds_read_b64_tr_b16 v[54:55], v6 offset:4608
    v_mfma_f32_32x32x16_bf16 v[80:95], v[60:63], v[160:163], v[80:95]
    ds_read_b64_tr_b16 v[56:57], v5 offset:6144
    ds_read_b64_tr_b16 v[58:59], v5 offset:6656
    s_waitcnt vmcnt(6) lgkmcnt(6)
    v_mfma_f32_32x32x16_bf16 v[64:79], v[40:43], v[164:167], v[64:79]
    ds_read_b64_tr_b16 v[60:61], v6 offset:6144
    ds_read_b64_tr_b16 v[62:63], v6 offset:6656
    v_mfma_f32_32x32x16_bf16 v[80:95], v[44:47], v[164:167], v[80:95]
    ds_read_b64_tr_b16 v[40:41], v5 offset:8192
    ds_read_b64_tr_b16 v[42:43], v5 offset:8704
    s_waitcnt vmcnt(5) lgkmcnt(6)
    v_mfma_f32_32x32x16_bf16 v[64:79], v[48:51], v[168:171], v[64:79]
    ds_read_b64_tr_b16 v[44:45], v6 offset:8192
    ds_read_b64_tr_b16 v[46:47], v6 offset:8704
    v_mfma_f32_32x32x16_bf16 v[80:95], v[52:55], v[168:171], v[80:95]
    ds_read_b64_tr_b16 v[48:49], v5 offset:10240
    ds_read_b64_tr_b16 v[50:51], v5 offset:10752
    s_waitcnt vmcnt(4) lgkmcnt(6)
    v_mfma_f32_32x32x16_bf16 v[64:79], v[56:59], v[172:175], v[64:79]
    ds_read_b64_tr_b16 v[52:53], v6 offset:10240
    ds_read_b64_tr_b16 v[54:55], v6 offset:10752
    v_mfma_f32_32x32x16_bf16 v[80:95], v[60:63], v[172:175], v[80:95]
    ds_read_b64_tr_b16 v[56:57], v5 offset:12288
    ds_read_b64_tr_b16 v[58:59], v5 offset:12800
    s_waitcnt vmcnt(3) lgkmcnt(6)
    v_mfma_f32_32x32x16_bf16 v[64:79], v[40:43], v[176:179], v[64:79]
    ds_read_b64_tr_b16 v[60:61], v6 offset:12288
    ds_read_b64_tr_b16 v[62:63], v6 offset:12800
    v_mfma_f32_32x32x16_bf16 v[80:95], v[44:47], v[176:179], v[80:95]
    ds_read_b64_tr_b16 v[40:41], v5 offset:14336
    ds_read_b64_tr_b16 v[42:43], v5 offset:14848
    s_waitcnt vmcnt(2) lgkmcnt(6)
    v_mfma_f32_32x32x16_bf16 v[64:79], v[48:51], v[180:183], v[64:79]
    ds_read_b64_tr_b16 v[44:45], v6 offset:14336
    ds_read_b64_tr_b16 v[46:47], v6 offset:14848
    v_mfma_f32_32x32x16_bf16 v[80:95], v[52:55], v[180:183], v[80:95]
    s_waitcnt vmcnt(1) lgkmcnt(4)
    v_mfma_f32_32x32x16_bf16 v[64:79], v[56:59], v[184:187], v[64:79]
    v_mfma_f32_32x32x16_bf16 v[80:95], v[60:63], v[184:187], v[80:95]
    s_waitcnt vmcnt(0) lgkmcnt(0)
    v_mfma_f32_32x32x16_bf16 v[64:79], v[40:43], v[188:191], v[64:79]
    v_mfma_f32_32x32x16_bf16 v[80:95], v[44:47], v[188:191], v[80:95]
    s_lshl_b32 s57, s20, 12
    s_add_u32 s57, s57, 131072
    v_add_u32 v8, s57, v1
    s_xor_b32 s58, s57, 0x2000
    v_add_u32 v9, s58, v1
    s_nop 6
    ds_write_b128 v8, v[80:83] offset:0
    ds_write_b128 v8, v[84:87] offset:1024
    ds_write_b128 v8, v[88:91] offset:2048
    ds_write_b128 v8, v[92:95] offset:3072
    s_waitcnt lgkmcnt(0)
    s_barrier
    ds_read_b128 v[96:99], v9 offset:0
    ds_read_b128 v[100:103], v9 offset:1024
    ds_read_b128 v[104:107], v9 offset:2048
    ds_read_b128 v[108:111], v9 offset:3072
    s_waitcnt lgkmcnt(3)
    v_pk_add_f32 v[64:65], v[64:65], v[96:97]
    v_pk_add_f32 v[66:67], v[66:67], v[98:99]
    s_waitcnt lgkmcnt(2)
    v_pk_add_f32 v[68:69], v[68:69], v[100:101]
    v_pk_add_f32 v[70:71], v[70:71], v[102:103]
    s_waitcnt lgkmcnt(1)
    v_pk_add_f32 v[72:73], v[72:73], v[104:105]
    v_pk_add_f32 v[74:75], v[74:75], v[106:107]
    s_waitcnt lgkmcnt(0)
    v_pk_add_f32 v[76:77], v[76:77], v[108:109]
    v_pk_add_f32 v[78:79], v[78:79], v[110:111]
    v_cvt_pk_bf16_f32 v16, v64, v65
    v_cvt_pk_bf16_f32 v17, v66, v67
    v_cvt_pk_bf16_f32 v18, v68, v69
    v_cvt_pk_bf16_f32 v19, v70, v71
    v_cvt_pk_bf16_f32 v20, v72, v73
    v_cvt_pk_bf16_f32 v21, v74, v75
    v_cvt_pk_bf16_f32 v22, v76, v77
    v_cvt_pk_bf16_f32 v23, v78, v79
    v_pk_mul_f32 v[96:97], v[64:65], v[64:65]
    v_pk_add_f32 v[98:99], v[64:65], v[66:67]
    v_pk_fma_f32 v[96:97], v[66:67], v[66:67], v[96:97]
    v_pk_add_f32 v[98:99], v[98:99], v[68:69]
    v_pk_fma_f32 v[96:97], v[68:69], v[68:69], v[96:97]
    v_pk_add_f32 v[98:99], v[98:99], v[70:71]
    v_pk_fma_f32 v[96:97], v[70:71], v[70:71], v[96:97]
    v_pk_add_f32 v[98:99], v[98:99], v[72:73]
    v_pk_fma_f32 v[96:97], v[72:73], v[72:73], v[96:97]
    v_pk_add_f32 v[98:99], v[98:99], v[74:75]
    v_pk_fma_f32 v[96:97], v[74:75], v[74:75], v[96:97]
    v_pk_add_f32 v[98:99], v[98:99], v[76:77]
    v_pk_fma_f32 v[96:97], v[76:77], v[76:77], v[96:97]
    v_pk_add_f32 v[98:99], v[98:99], v[78:79]
    v_pk_fma_f32 v[96:97], v[78:79], v[78:79], v[96:97]
    v_permlane32_swap_b32 v16, v18
    v_permlane32_swap_b32 v17, v19
    v_permlane32_swap_b32 v20, v22
    v_permlane32_swap_b32 v21, v23
    v_add_f32 v98, v98, v99
    v_add_f32 v96, v96, v97
    s_nop 1
    v_permlane32_swap_b32 v98, v96
    v_add_f32 v98, v98, v96
    v_and_b32 v10, 31, v0
    v_lshlrev_b32 v10, 4, v10
    v_lshrrev_b32 v11, 5, v0
    v_lshl_add_u32 v10, v11, 2, v10
    s_lshl_b32 s58, s53, 9
    s_lshl_b32 s59, s51, 3
    s_add_u32 s81, s58, s59
    s_add_u32 s57, s80, s73
    buffer_store_dwordx4 v[16:19], v1, s[32:35], s57 offen offset:0
    buffer_store_dwordx4 v[16:19], v1, s[36:39], s57 offen offset:0 sc1
    buffer_store_dwordx4 v[20:23], v1, s[32:35], s57 offen offset:1024
    buffer_store_dwordx4 v[20:23], v1, s[36:39], s57 offen offset:1024 sc1
    s_lshl_b32 s58, s55, 12
    s_add_u32 s58, s58, s81
    s_add_u32 s58, s58, s74
    buffer_store_dword v98, v10, s[32:35], s58 offen offset:0
    buffer_store_dword v98, v10, s[36:39], s58 offen offset:0 sc1
    s_add_u32 s49, s49, 1
    s_waitcnt vmcnt(0)
    s_add_u32 s57, s23, s49
    v_mov_b32 v7, s57
    s_mov_b64 exec, 1
    buffer_store_dword v7, v4, s[32:35], 0 offen
    buffer_store_dword v7, v4, s[36:39], 0 offen sc1
    s_mov_b64 exec, -1
    s_mov_b32 s58, 0x55555555
    s_lshl_b32 s58, s58, s50
    s_cmp_eq_u32 s51, 0
    s_cselect_b32 s64, s58, 0
    s_cselect_b32 s65, 0, s58
    v_lshrrev_b32 v12, 5, v0
    v_mul_u32_u24 v12, 1536, v12
    v_bfe_u32 v13, v0, 2, 2
    v_mul_u32_u24 v13, 192, v13
    v_add_u32 v12, v12, v13
    v_bfe_u32 v13, v0, 4, 1
    v_lshl_add_u32 v12, v13, 5, v12
    v_and_b32 v13, 3, v0
    v_lshl_add_u32 v12, v13, 3, v12
    v_and_b32 v7, 31, v0
    v_lshlrev_b32 v7, 4, v7
    v_lshlrev_b32 v15, 3, v0
    v_add_u32 v15, 158720, v15
    s_lshl_b32 s57, s22, 3
    s_mul_hi_u32 s57, s57, 0x55555556
    s_lshl_b32 s57, s57, 11
    s_mul_i32 s84, s54, 88064
    s_add_u32 s84, s84, s57
    s_add_u32 s84, s84, s75
    s_add_u32 s68, s23, s49
    s_mov_b32 s69, 0
Lpoll_C_17:
    buffer_load_dword v14, v3, s[28:31], 0 offen sc1
    s_add_u32 s69, s69, 1
    s_waitcnt vmcnt(0)
    v_subrev_u32 v14, s68, v14
    v_cmp_gt_u32 vcc, 16, v14
    s_nop 1
    s_and_b64 s[66:67], vcc, s[64:65]
    s_cmp_eq_u64 s[66:67], s[64:65]
    s_cbranch_scc1 Lpdone_C_18
    s_cmp_lt_u32 s69, 262144
    s_cbranch_scc1 Lpoll_C_17
Lpdone_C_18:
    s_nop 1
    s_lshl_b32 s78, s54, 15
    s_add_u32 s78, s78, s73
    s_lshl_b32 s79, s54, 12
    s_add_u32 s79, s79, s74
    buffer_load_dwordx4 v[160:163], v1, s[28:31], s78 offen offset:0 sc1
    buffer_load_dwordx4 v[164:167], v1, s[28:31], s78 offen offset:1024 sc1
    buffer_load_dwordx4 v[168:171], v1, s[28:31], s78 offen offset:2048 sc1
    s_barrier
    s_add_u32 s57, s56, 163840
    s_and_b32 s57, s57, 0x1ffff
    v_add_u32 v5, s57, v12
    ds_read_b64_tr_b16 v[40:41], v5 offset:0
    ds_read_b64_tr_b16 v[42:43], v5 offset:768
    s_add_u32 s57, s56, 180224
    s_and_b32 s57, s57, 0x1ffff
    v_add_u32 v6, s57, v12
    ds_read_b64_tr_b16 v[44:45], v6 offset:0
    ds_read_b64_tr_b16 v[46:47], v6 offset:768
    ds_read_b64_tr_b16 v[48:49], v5 offset:64
    ds_read_b64_tr_b16 v[50:51], v5 offset:832
    ds_read_b64_tr_b16 v[52:53], v6 offset:64
    ds_read_b64_tr_b16 v[54:55], v6 offset:832
    ds_read_b64_tr_b16 v[56:57], v5 offset:128
    ds_read_b64_tr_b16 v[58:59], v5 offset:896
    s_waitcnt vmcnt(2) lgkmcnt(6)
    v_mfma_f32_32x32x16_bf16 v[64:79], v[40:43], v[160:163], 0
    ds_read_b64_tr_b16 v[60:61], v6 offset:128
    ds_read_b64_tr_b16 v[62:63], v6 offset:896
    buffer_load_dwordx4 v[224:227], v7, s[28:31], s79 offen offset:0 sc1
    v_mfma_f32_32x32x16_bf16 v[80:95], v[44:47], v[160:163], 0
    ds_read_b64_tr_b16 v[40:41], v5 offset:3072
    ds_read_b64_tr_b16 v[42:43], v5 offset:3840
    buffer_load_dwordx4 v[228:231], v7, s[28:31], s79 offen offset:512 sc1
    s_waitcnt lgkmcnt(6)
    v_mfma_f32_32x32x16_bf16 v[96:111], v[48:51], v[160:163], 0
    ds_read_b64_tr_b16 v[44:45], v6 offset:3072
    ds_read_b64_tr_b16 v[46:47], v6 offset:3840
    buffer_load_dwordx4 v[232:235], v7, s[28:31], s79 offen offset:1024 sc1
    v_mfma_f32_32x32x16_bf16 v[112:127], v[52:55], v[160:163], 0
    ds_read_b64_tr_b16 v[48:49], v5 offset:3136
    ds_read_b64_tr_b16 v[50:51], v5 offset:3904
    buffer_load_dwordx4 v[236:239], v7, s[28:31], s79 offen offset:1536 sc1
    s_waitcnt lgkmcnt(6)
    v_mfma_f32_32x32x16_bf16 v[128:143], v[56:59], v[160:163], 0
    ds_read_b64_tr_b16 v[52:53], v6 offset:3136
    ds_read_b64_tr_b16 v[54:55], v6 offset:3904
    buffer_load_dwordx4 v[240:243], v7, s[28:31], s79 offen offset:2048 sc1
    v_mfma_f32_32x32x16_bf16 v[144:159], v[60:63], v[160:163], 0
    ds_read_b64_tr_b16 v[56:57], v5 offset:3200
    ds_read_b64_tr_b16 v[58:59], v5 offset:3968
    buffer_load_dwordx4 v[244:247], v7, s[28:31], s79 offen offset:2560 sc1
    s_waitcnt vmcnt(7) lgkmcnt(6)
    v_mfma_f32_32x32x16_bf16 v[64:79], v[40:43], v[164:167], v[64:79]
    ds_read_b64_tr_b16 v[60:61], v6 offset:3200
    ds_read_b64_tr_b16 v[62:63], v6 offset:3968
    buffer_load_dwordx4 v[248:251], v7, s[28:31], s79 offen offset:3072 sc1
    v_mfma_f32_32x32x16_bf16 v[80:95], v[44:47], v[164:167], v[80:95]
    ds_read_b64_tr_b16 v[40:41], v5 offset:6144
    ds_read_b64_tr_b16 v[42:43], v5 offset:6912
    buffer_load_dwordx4 v[252:255], v7, s[28:31], s79 offen offset:3584 sc1
    s_waitcnt lgkmcnt(6)
    v_mfma_f32_32x32x16_bf16 v[96:111], v[48:51], v[164:167], v[96:111]
    ds_read_b64_tr_b16 v[44:45], v6 offset:6144
    ds_read_b64_tr_b16 v[46:47], v6 offset:6912
    buffer_load_dwordx4 v[172:175], v1, s[28:31], s78 offen offset:3072 sc1
    v_mfma_f32_32x32x16_bf16 v[112:127], v[52:55], v[164:167], v[112:127]
    ds_read_b64_tr_b16 v[48:49], v5 offset:6208
    ds_read_b64_tr_b16 v[50:51], v5 offset:6976
    s_waitcnt lgkmcnt(6)
    v_mfma_f32_32x32x16_bf16 v[128:143], v[56:59], v[164:167], v[128:143]
    ds_read_b64_tr_b16 v[52:53], v6 offset:6208
    ds_read_b64_tr_b16 v[54:55], v6 offset:6976
    s_add_u32 s78, s78, 4096
    buffer_load_dwordx4 v[176:179], v1, s[28:31], s78 offen offset:0 sc1
    s_waitcnt vmcnt(2)
    v_add_f32 v224, v224, v226
    v_mfma_f32_32x32x16_bf16 v[144:159], v[60:63], v[164:167], v[144:159]
    ds_read_b64_tr_b16 v[56:57], v5 offset:6272
    ds_read_b64_tr_b16 v[58:59], v5 offset:7040
    v_add_f32 v228, v228, v230
    v_add_f32 v232, v232, v234
    v_add_f32 v236, v236, v238
    s_waitcnt lgkmcnt(6)
    v_mfma_f32_32x32x16_bf16 v[64:79], v[40:43], v[168:171], v[64:79]
    ds_read_b64_tr_b16 v[60:61], v6 offset:6272
    ds_read_b64_tr_b16 v[62:63], v6 offset:7040
    buffer_load_dwordx4 v[180:183], v1, s[28:31], s78 offen offset:1024 sc1
    v_add_f32 v240, v240, v242
    v_add_f32 v244, v244, v246
    v_mfma_f32_32x32x16_bf16 v[80:95], v[44:47], v[168:171], v[80:95]
    ds_read_b64_tr_b16 v[40:41], v5 offset:9216
    ds_read_b64_tr_b16 v[42:43], v5 offset:9984
    v_add_f32 v248, v248, v250
    v_add_f32 v252, v252, v254
    v_add_f32 v224, v224, v228
    s_waitcnt lgkmcnt(6)
    v_mfma_f32_32x32x16_bf16 v[96:111], v[48:51], v[168:171], v[96:111]
    ds_read_b64_tr_b16 v[44:45], v6 offset:9216
    ds_read_b64_tr_b16 v[46:47], v6 offset:9984
    buffer_load_dwordx4 v[184:187], v1, s[28:31], s78 offen offset:2048 sc1
    v_add_f32 v232, v232, v236
    v_add_f32 v240, v240, v244
    v_mfma_f32_32x32x16_bf16 v[112:127], v[52:55], v[168:171], v[112:127]
    ds_read_b64_tr_b16 v[48:49], v5 offset:9280
    ds_read_b64_tr_b16 v[50:51], v5 offset:10048
    v_add_f32 v248, v248, v252
    v_add_f32 v224, v224, v232
    v_add_f32 v240, v240, v248
    s_waitcnt lgkmcnt(6)
    v_mfma_f32_32x32x16_bf16 v[128:143], v[56:59], v[168:171], v[128:143]
    ds_read_b64_tr_b16 v[52:53], v6 offset:9280
    ds_read_b64_tr_b16 v[54:55], v6 offset:10048
    buffer_load_dwordx4 v[188:191], v1, s[28:31], s78 offen offset:3072 sc1
    v_add_f32 v224, v224, v240
    v_add_f32 v225, v225, v227
    v_mfma_f32_32x32x16_bf16 v[144:159], v[60:63], v[168:171], v[144:159]
    ds_read_b64_tr_b16 v[56:57], v5 offset:9344
    ds_read_b64_tr_b16 v[58:59], v5 offset:10112
    v_add_f32 v229, v229, v231
    v_add_f32 v233, v233, v235
    v_add_f32 v237, v237, v239
    s_waitcnt vmcnt(4) lgkmcnt(6)
    v_mfma_f32_32x32x16_bf16 v[64:79], v[40:43], v[172:175], v[64:79]
    ds_read_b64_tr_b16 v[60:61], v6 offset:9344
    ds_read_b64_tr_b16 v[62:63], v6 offset:10112
    s_add_u32 s78, s78, 4096
    buffer_load_dwordx4 v[192:195], v1, s[28:31], s78 offen offset:0 sc1
    v_add_f32 v241, v241, v243
    v_mfma_f32_32x32x16_bf16 v[80:95], v[44:47], v[172:175], v[80:95]
    ds_read_b64_tr_b16 v[40:41], v5 offset:12288
    ds_read_b64_tr_b16 v[42:43], v5 offset:13056
    v_add_f32 v245, v245, v247
    v_add_f32 v249, v249, v251
    v_add_f32 v253, v253, v255
    s_waitcnt lgkmcnt(6)
    v_mfma_f32_32x32x16_bf16 v[96:111], v[48:51], v[172:175], v[96:111]
    ds_read_b64_tr_b16 v[44:45], v6 offset:12288
    ds_read_b64_tr_b16 v[46:47], v6 offset:13056
    buffer_load_dwordx4 v[196:199], v1, s[28:31], s78 offen offset:1024 sc1
    v_add_f32 v225, v225, v229
    v_add_f32 v233, v233, v237
    v_mfma_f32_32x32x16_bf16 v[112:127], v[52:55], v[172:175], v[112:127]
    ds_read_b64_tr_b16 v[48:49], v5 offset:12352
    ds_read_b64_tr_b16 v[50:51], v5 offset:13120
    v_add_f32 v241, v241, v245
    v_add_f32 v249, v249, v253
    v_add_f32 v225, v225, v233
    s_waitcnt lgkmcnt(6)
    v_mfma_f32_32x32x16_bf16 v[128:143], v[56:59], v[172:175], v[128:143]
    ds_read_b64_tr_b16 v[52:53], v6 offset:12352
    ds_read_b64_tr_b16 v[54:55], v6 offset:13120
    buffer_load_dwordx4 v[200:203], v1, s[28:31], s78 offen offset:2048 sc1
    v_add_f32 v241, v241, v249
    v_add_f32 v225, v225, v241
    v_mfma_f32_32x32x16_bf16 v[144:159], v[60:63], v[172:175], v[144:159]
    ds_read_b64_tr_b16 v[56:57], v5 offset:12416
    ds_read_b64_tr_b16 v[58:59], v5 offset:13184
    v_mul_f32 v11, 0x3b000000, v224
    v_mul_f32 v13, 0x3b000000, v225
    v_fma_f32 v13, -v11, v11, v13
    s_waitcnt vmcnt(6) lgkmcnt(6)
    v_mfma_f32_32x32x16_bf16 v[64:79], v[40:43], v[176:179], v[64:79]
    ds_read_b64_tr_b16 v[60:61], v6 offset:12416
    ds_read_b64_tr_b16 v[62:63], v6 offset:13184
    buffer_load_dwordx4 v[204:207], v1, s[28:31], s78 offen offset:3072 sc1
    v_max_f32 v13, 0, v13
    v_cvt_pk_bf16_f32 v14, v11, v11
    v_mfma_f32_32x32x16_bf16 v[80:95], v[44:47], v[176:179], v[80:95]
    s_add_u32 s57, s56, 196608
    s_and_b32 s57, s57, 0x1ffff
    v_add_u32 v5, s57, v12
    ds_read_b64_tr_b16 v[40:41], v5 offset:0
    ds_read_b64_tr_b16 v[42:43], v5 offset:768
    v_cvt_pk_bf16_f32 v13, v13, v13
    v_xor_b32 v28, 0x80008000, v14
    v_and_b32 v13, 0xffff0000, v13
    s_waitcnt lgkmcnt(6)
    v_mfma_f32_32x32x16_bf16 v[96:111], v[48:51], v[176:179], v[96:111]
    s_add_u32 s57, s56, 212992
    s_and_b32 s57, s57, 0x1ffff
    v_add_u32 v6, s57, v12
    ds_read_b64_tr_b16 v[44:45], v6 offset:0
    ds_read_b64_tr_b16 v[46:47], v6 offset:768
    s_add_u32 s78, s78, 4096
    buffer_load_dwordx4 v[208:211], v1, s[28:31], s78 offen offset:0 sc1
    v_and_b32 v29, 0xffff, v28
    v_mfma_f32_32x32x16_bf16 v[112:127], v[52:55], v[176:179], v[112:127]
    ds_read_b64_tr_b16 v[48:49], v5 offset:64
    ds_read_b64_tr_b16 v[50:51], v5 offset:832
    v_add_f32 v13, 0x3727c5ac, v13
    v_cvt_pk_bf16_f32 v13, v13, v13
    v_and_b32 v13, 0xffff0000, v13
    s_waitcnt lgkmcnt(6)
    v_mfma_f32_32x32x16_bf16 v[128:143], v[56:59], v[176:179], v[128:143]
    ds_read_b64_tr_b16 v[52:53], v6 offset:64
    ds_read_b64_tr_b16 v[54:55], v6 offset:832
    buffer_load_dwordx4 v[212:215], v1, s[28:31], s78 offen offset:1024 sc1
    v_sqrt_f32 v13, v13
    v_mfma_f32_32x32x16_bf16 v[144:159], v[60:63], v[176:179], v[144:159]
    ds_read_b64_tr_b16 v[56:57], v5 offset:128
    ds_read_b64_tr_b16 v[58:59], v5 offset:896
    s_barrier
    v_cvt_pk_bf16_f32 v13, v13, v13
    v_and_b32 v13, 0xffff0000, v13
    s_waitcnt vmcnt(8) lgkmcnt(6)
    v_mfma_f32_32x32x16_bf16 v[64:79], v[40:43], v[180:183], v[64:79]
    ds_read_b64_tr_b16 v[60:61], v6 offset:128
    ds_read_b64_tr_b16 v[62:63], v6 offset:896
    buffer_load_dwordx4 v[216:219], v1, s[28:31], s78 offen offset:2048 sc1
    v_rcp_f32 v11, v13
    v_mfma_f32_32x32x16_bf16 v[80:95], v[44:47], v[180:183], v[80:95]
    ds_read_b64_tr_b16 v[40:41], v5 offset:3072
    ds_read_b64_tr_b16 v[42:43], v5 offset:3840
    v_mul_f32 v10, v13, v13
    v_mul_f32 v8, 0xc0135761, v11
    v_mul_f32 v14, v11, v11
    s_waitcnt lgkmcnt(6)
    v_mfma_f32_32x32x16_bf16 v[96:111], v[48:51], v[180:183], v[96:111]
    ds_read_b64_tr_b16 v[44:45], v6 offset:3072
    ds_read_b64_tr_b16 v[46:47], v6 offset:3840
    buffer_load_dwordx4 v[220:223], v1, s[28:31], s78 offen offset:3072 sc1
    v_mul_f32 v14, 0x3d372713, v14
    v_mul_f32 v9, v8, v14
    v_mfma_f32_32x32x16_bf16 v[112:127], v[52:55], v[180:183], v[112:127]
    ds_read_b64_tr_b16 v[48:49], v5 offset:3136
    ds_read_b64_tr_b16 v[50:51], v5 offset:3904
    s_waitcnt lgkmcnt(6)
    v_mfma_f32_32x32x16_bf16 v[128:143], v[56:59], v[180:183], v[128:143]
    ds_read_b64_tr_b16 v[52:53], v6 offset:3136
    ds_read_b64_tr_b16 v[54:55], v6 offset:3904
    v_mfma_f32_32x32x16_bf16 v[144:159], v[60:63], v[180:183], v[144:159]
    ds_read_b64_tr_b16 v[56:57], v5 offset:3200
    ds_read_b64_tr_b16 v[58:59], v5 offset:3968
    s_waitcnt vmcnt(9) lgkmcnt(6)
    v_mfma_f32_32x32x16_bf16 v[64:79], v[40:43], v[184:187], v[64:79]
    ds_read_b64_tr_b16 v[60:61], v6 offset:3200
    ds_read_b64_tr_b16 v[62:63], v6 offset:3968
    s_add_u32 s78, s78, 4096
    buffer_load_dwordx4 v[224:227], v1, s[28:31], s78 offen offset:0 sc1
    v_mfma_f32_32x32x16_bf16 v[80:95], v[44:47], v[184:187], v[80:95]
    ds_read_b64_tr_b16 v[40:41], v5 offset:6144
    ds_read_b64_tr_b16 v[42:43], v5 offset:6912
    s_waitcnt lgkmcnt(6)
    v_mfma_f32_32x32x16_bf16 v[96:111], v[48:51], v[184:187], v[96:111]
    ds_read_b64_tr_b16 v[44:45], v6 offset:6144
    ds_read_b64_tr_b16 v[46:47], v6 offset:6912
    v_mfma_f32_32x32x16_bf16 v[112:127], v[52:55], v[184:187], v[112:127]
    ds_read_b64_tr_b16 v[48:49], v5 offset:6208
    ds_read_b64_tr_b16 v[50:51], v5 offset:6976
    s_waitcnt lgkmcnt(6)
    v_mfma_f32_32x32x16_bf16 v[128:143], v[56:59], v[184:187], v[128:143]
    ds_read_b64_tr_b16 v[52:53], v6 offset:6208
    ds_read_b64_tr_b16 v[54:55], v6 offset:6976
    v_mfma_f32_32x32x16_bf16 v[144:159], v[60:63], v[184:187], v[144:159]
    ds_read_b64_tr_b16 v[56:57], v5 offset:6272
    ds_read_b64_tr_b16 v[58:59], v5 offset:7040
    s_waitcnt vmcnt(9) lgkmcnt(6)
    v_mfma_f32_32x32x16_bf16 v[64:79], v[40:43], v[188:191], v[64:79]
    ds_read_b64_tr_b16 v[60:61], v6 offset:6272
    ds_read_b64_tr_b16 v[62:63], v6 offset:7040
    buffer_load_dwordx4 v[228:231], v1, s[28:31], s78 offen offset:1024 sc1
    v_mfma_f32_32x32x16_bf16 v[80:95], v[44:47], v[188:191], v[80:95]
    ds_read_b64_tr_b16 v[40:41], v5 offset:9216
    ds_read_b64_tr_b16 v[42:43], v5 offset:9984
    s_waitcnt lgkmcnt(6)
    v_mfma_f32_32x32x16_bf16 v[96:111], v[48:51], v[188:191], v[96:111]
    ds_read_b64_tr_b16 v[44:45], v6 offset:9216
    ds_read_b64_tr_b16 v[46:47], v6 offset:9984
    v_mfma_f32_32x32x16_bf16 v[112:127], v[52:55], v[188:191], v[112:127]
    ds_read_b64_tr_b16 v[48:49], v5 offset:9280
    ds_read_b64_tr_b16 v[50:51], v5 offset:10048
    s_waitcnt lgkmcnt(6)
    v_mfma_f32_32x32x16_bf16 v[128:143], v[56:59], v[188:191], v[128:143]
    ds_read_b64_tr_b16 v[52:53], v6 offset:9280
    ds_read_b64_tr_b16 v[54:55], v6 offset:10048
    v_mfma_f32_32x32x16_bf16 v[144:159], v[60:63], v[188:191], v[144:159]
    ds_read_b64_tr_b16 v[56:57], v5 offset:9344
    ds_read_b64_tr_b16 v[58:59], v5 offset:10112
    s_waitcnt vmcnt(9) lgkmcnt(6)
    v_mfma_f32_32x32x16_bf16 v[64:79], v[40:43], v[192:195], v[64:79]
    ds_read_b64_tr_b16 v[60:61], v6 offset:9344
    ds_read_b64_tr_b16 v[62:63], v6 offset:10112
    buffer_load_dwordx4 v[232:235], v1, s[28:31], s78 offen offset:2048 sc1
    v_mfma_f32_32x32x16_bf16 v[80:95], v[44:47], v[192:195], v[80:95]
    ds_read_b64_tr_b16 v[40:41], v5 offset:12288
    ds_read_b64_tr_b16 v[42:43], v5 offset:13056
    s_waitcnt lgkmcnt(6)
    v_mfma_f32_32x32x16_bf16 v[96:111], v[48:51], v[192:195], v[96:111]
    ds_read_b64_tr_b16 v[44:45], v6 offset:12288
    ds_read_b64_tr_b16 v[46:47], v6 offset:13056
    v_mfma_f32_32x32x16_bf16 v[112:127], v[52:55], v[192:195], v[112:127]
    ds_read_b64_tr_b16 v[48:49], v5 offset:12352
    ds_read_b64_tr_b16 v[50:51], v5 offset:13120
    s_waitcnt lgkmcnt(6)
    v_mfma_f32_32x32x16_bf16 v[128:143], v[56:59], v[192:195], v[128:143]
    ds_read_b64_tr_b16 v[52:53], v6 offset:12352
    ds_read_b64_tr_b16 v[54:55], v6 offset:13120
    v_mfma_f32_32x32x16_bf16 v[144:159], v[60:63], v[192:195], v[144:159]
    ds_read_b64_tr_b16 v[56:57], v5 offset:12416
    ds_read_b64_tr_b16 v[58:59], v5 offset:13184
    s_waitcnt vmcnt(9) lgkmcnt(6)
    v_mfma_f32_32x32x16_bf16 v[64:79], v[40:43], v[196:199], v[64:79]
    ds_read_b64_tr_b16 v[60:61], v6 offset:12416
    ds_read_b64_tr_b16 v[62:63], v6 offset:13184
    buffer_load_dwordx4 v[236:239], v1, s[28:31], s78 offen offset:3072 sc1
    v_mfma_f32_32x32x16_bf16 v[80:95], v[44:47], v[196:199], v[80:95]
    s_add_u32 s57, s56, 229376
    s_and_b32 s57, s57, 0x1ffff
    v_add_u32 v5, s57, v12
    ds_read_b64_tr_b16 v[40:41], v5 offset:0
    ds_read_b64_tr_b16 v[42:43], v5 offset:768
    s_waitcnt lgkmcnt(6)
    v_mfma_f32_32x32x16_bf16 v[96:111], v[48:51], v[196:199], v[96:111]
    s_add_u32 s57, s56, 245760
    s_and_b32 s57, s57, 0x1ffff
    v_add_u32 v6, s57, v12
    ds_read_b64_tr_b16 v[44:45], v6 offset:0
    ds_read_b64_tr_b16 v[46:47], v6 offset:768
    v_mfma_f32_32x32x16_bf16 v[112:127], v[52:55], v[196:199], v[112:127]
    ds_read_b64_tr_b16 v[48:49], v5 offset:64
    ds_read_b64_tr_b16 v[50:51], v5 offset:832
    s_waitcnt lgkmcnt(6)
    v_mfma_f32_32x32x16_bf16 v[128:143], v[56:59], v[196:199], v[128:143]
    ds_read_b64_tr_b16 v[52:53], v6 offset:64
    ds_read_b64_tr_b16 v[54:55], v6 offset:832
    v_mfma_f32_32x32x16_bf16 v[144:159], v[60:63], v[196:199], v[144:159]
    ds_read_b64_tr_b16 v[56:57], v5 offset:128
    ds_read_b64_tr_b16 v[58:59], v5 offset:896
    s_barrier
    s_waitcnt vmcnt(9) lgkmcnt(6)
    v_mfma_f32_32x32x16_bf16 v[64:79], v[40:43], v[200:203], v[64:79]
    ds_read_b64_tr_b16 v[60:61], v6 offset:128
    ds_read_b64_tr_b16 v[62:63], v6 offset:896
    s_add_u32 s78, s78, 4096
    buffer_load_dwordx4 v[240:243], v1, s[28:31], s78 offen offset:0 sc1
    v_mfma_f32_32x32x16_bf16 v[80:95], v[44:47], v[200:203], v[80:95]
    ds_read_b64_tr_b16 v[40:41], v5 offset:3072
    ds_read_b64_tr_b16 v[42:43], v5 offset:3840
    s_waitcnt lgkmcnt(6)
    v_mfma_f32_32x32x16_bf16 v[96:111], v[48:51], v[200:203], v[96:111]
    ds_read_b64_tr_b16 v[44:45], v6 offset:3072
    ds_read_b64_tr_b16 v[46:47], v6 offset:3840
    v_mfma_f32_32x32x16_bf16 v[112:127], v[52:55], v[200:203], v[112:127]
    ds_read_b64_tr_b16 v[48:49], v5 offset:3136
    ds_read_b64_tr_b16 v[50:51], v5 offset:3904
    s_waitcnt lgkmcnt(6)
    v_mfma_f32_32x32x16_bf16 v[128:143], v[56:59], v[200:203], v[128:143]
    ds_read_b64_tr_b16 v[52:53], v6 offset:3136
    ds_read_b64_tr_b16 v[54:55], v6 offset:3904
    v_mfma_f32_32x32x16_bf16 v[144:159], v[60:63], v[200:203], v[144:159]
    ds_read_b64_tr_b16 v[56:57], v5 offset:3200
    ds_read_b64_tr_b16 v[58:59], v5 offset:3968
    s_waitcnt vmcnt(9) lgkmcnt(6)
    v_mfma_f32_32x32x16_bf16 v[64:79], v[40:43], v[204:207], v[64:79]
    ds_read_b64_tr_b16 v[60:61], v6 offset:3200
    ds_read_b64_tr_b16 v[62:63], v6 offset:3968
    buffer_load_dwordx4 v[244:247], v1, s[28:31], s78 offen offset:1024 sc1
    v_mfma_f32_32x32x16_bf16 v[80:95], v[44:47], v[204:207], v[80:95]
    ds_read_b64_tr_b16 v[40:41], v5 offset:6144
    ds_read_b64_tr_b16 v[42:43], v5 offset:6912
    s_waitcnt lgkmcnt(6)
    v_mfma_f32_32x32x16_bf16 v[96:111], v[48:51], v[204:207], v[96:111]
    ds_read_b64_tr_b16 v[44:45], v6 offset:6144
    ds_read_b64_tr_b16 v[46:47], v6 offset:6912
    v_mfma_f32_32x32x16_bf16 v[112:127], v[52:55], v[204:207], v[112:127]
    ds_read_b64_tr_b16 v[48:49], v5 offset:6208
    ds_read_b64_tr_b16 v[50:51], v5 offset:6976
    s_waitcnt lgkmcnt(6)
    v_mfma_f32_32x32x16_bf16 v[128:143], v[56:59], v[204:207], v[128:143]
    ds_read_b64_tr_b16 v[52:53], v6 offset:6208
    ds_read_b64_tr_b16 v[54:55], v6 offset:6976
    v_mfma_f32_32x32x16_bf16 v[144:159], v[60:63], v[204:207], v[144:159]
    ds_read_b64_tr_b16 v[56:57], v5 offset:6272
    ds_read_b64_tr_b16 v[58:59], v5 offset:7040
    s_waitcnt vmcnt(9) lgkmcnt(6)
    v_mfma_f32_32x32x16_bf16 v[64:79], v[40:43], v[208:211], v[64:79]
    ds_read_b64_tr_b16 v[60:61], v6 offset:6272
    ds_read_b64_tr_b16 v[62:63], v6 offset:7040
    buffer_load_dwordx4 v[248:251], v1, s[28:31], s78 offen offset:2048 sc1
    v_mfma_f32_32x32x16_bf16 v[80:95], v[44:47], v[208:211], v[80:95]
    ds_read_b64_tr_b16 v[40:41], v5 offset:9216
    ds_read_b64_tr_b16 v[42:43], v5 offset:9984
    s_waitcnt lgkmcnt(6)
    v_mfma_f32_32x32x16_bf16 v[96:111], v[48:51], v[208:211], v[96:111]
    ds_read_b64_tr_b16 v[44:45], v6 offset:9216
    ds_read_b64_tr_b16 v[46:47], v6 offset:9984
    v_mfma_f32_32x32x16_bf16 v[112:127], v[52:55], v[208:211], v[112:127]
    ds_read_b64_tr_b16 v[48:49], v5 offset:9280
    ds_read_b64_tr_b16 v[50:51], v5 offset:10048
    s_waitcnt lgkmcnt(6)
    v_mfma_f32_32x32x16_bf16 v[128:143], v[56:59], v[208:211], v[128:143]
    ds_read_b64_tr_b16 v[52:53], v6 offset:9280
    ds_read_b64_tr_b16 v[54:55], v6 offset:10048
    v_mfma_f32_32x32x16_bf16 v[144:159], v[60:63], v[208:211], v[144:159]
    ds_read_b64_tr_b16 v[56:57], v5 offset:9344
    ds_read_b64_tr_b16 v[58:59], v5 offset:10112
    s_waitcnt vmcnt(9) lgkmcnt(6)
    v_mfma_f32_32x32x16_bf16 v[64:79], v[40:43], v[212:215], v[64:79]
    ds_read_b64_tr_b16 v[60:61], v6 offset:9344
    ds_read_b64_tr_b16 v[62:63], v6 offset:10112
    buffer_load_dwordx4 v[252:255], v1, s[28:31], s78 offen offset:3072 sc1
    v_mfma_f32_32x32x16_bf16 v[80:95], v[44:47], v[212:215], v[80:95]
    ds_read_b64_tr_b16 v[40:41], v5 offset:12288
    ds_read_b64_tr_b16 v[42:43], v5 offset:13056
    s_waitcnt lgkmcnt(6)
    v_mfma_f32_32x32x16_bf16 v[96:111], v[48:51], v[212:215], v[96:111]
    ds_read_b64_tr_b16 v[44:45], v6 offset:12288
    ds_read_b64_tr_b16 v[46:47], v6 offset:13056
    v_mfma_f32_32x32x16_bf16 v[112:127], v[52:55], v[212:215], v[112:127]
    ds_read_b64_tr_b16 v[48:49], v5 offset:12352
    ds_read_b64_tr_b16 v[50:51], v5 offset:13120
    s_waitcnt lgkmcnt(6)
    v_mfma_f32_32x32x16_bf16 v[128:143], v[56:59], v[212:215], v[128:143]
    ds_read_b64_tr_b16 v[52:53], v6 offset:12352
    ds_read_b64_tr_b16 v[54:55], v6 offset:13120
    v_mfma_f32_32x32x16_bf16 v[144:159], v[60:63], v[212:215], v[144:159]
    ds_read_b64_tr_b16 v[56:57], v5 offset:12416
    ds_read_b64_tr_b16 v[58:59], v5 offset:13184
    s_waitcnt vmcnt(9) lgkmcnt(6)
    v_mfma_f32_32x32x16_bf16 v[64:79], v[40:43], v[216:219], v[64:79]
    ds_read_b64_tr_b16 v[60:61], v6 offset:12416
    ds_read_b64_tr_b16 v[62:63], v6 offset:13184
    s_add_u32 s78, s78, 4096
    buffer_load_dwordx4 v[160:163], v1, s[28:31], s78 offen offset:0 sc1
    v_mfma_f32_32x32x16_bf16 v[80:95], v[44:47], v[216:219], v[80:95]
    s_add_u32 s57, s56, 262144
    s_and_b32 s57, s57, 0x1ffff
    v_add_u32 v5, s57, v12
    ds_read_b64_tr_b16 v[40:41], v5 offset:0
    ds_read_b64_tr_b16 v[42:43], v5 offset:768
    s_waitcnt lgkmcnt(6)
    v_mfma_f32_32x32x16_bf16 v[96:111], v[48:51], v[216:219], v[96:111]
    s_add_u32 s57, s56, 278528
    s_and_b32 s57, s57, 0x1ffff
    v_add_u32 v6, s57, v12
    ds_read_b64_tr_b16 v[44:45], v6 offset:0
    ds_read_b64_tr_b16 v[46:47], v6 offset:768
    v_mfma_f32_32x32x16_bf16 v[112:127], v[52:55], v[216:219], v[112:127]
    ds_read_b64_tr_b16 v[48:49], v5 offset:64
    ds_read_b64_tr_b16 v[50:51], v5 offset:832
    s_waitcnt lgkmcnt(6)
    v_mfma_f32_32x32x16_bf16 v[128:143], v[56:59], v[216:219], v[128:143]
    ds_read_b64_tr_b16 v[52:53], v6 offset:64
    ds_read_b64_tr_b16 v[54:55], v6 offset:832
    v_mfma_f32_32x32x16_bf16 v[144:159], v[60:63], v[216:219], v[144:159]
    ds_read_b64_tr_b16 v[56:57], v5 offset:128
    ds_read_b64_tr_b16 v[58:59], v5 offset:896
    s_barrier
    s_waitcnt vmcnt(9) lgkmcnt(6)
    v_mfma_f32_32x32x16_bf16 v[64:79], v[40:43], v[220:223], v[64:79]
    ds_read_b64_tr_b16 v[60:61], v6 offset:128
    ds_read_b64_tr_b16 v[62:63], v6 offset:896
    buffer_load_dwordx4 v[164:167], v1, s[28:31], s78 offen offset:1024 sc1
    v_mfma_f32_32x32x16_bf16 v[80:95], v[44:47], v[220:223], v[80:95]
    ds_read_b64_tr_b16 v[40:41], v5 offset:3072
    ds_read_b64_tr_b16 v[42:43], v5 offset:3840
    s_waitcnt lgkmcnt(6)
    v_mfma_f32_32x32x16_bf16 v[96:111], v[48:51], v[220:223], v[96:111]
    ds_read_b64_tr_b16 v[44:45], v6 offset:3072
    ds_read_b64_tr_b16 v[46:47], v6 offset:3840
    v_mfma_f32_32x32x16_bf16 v[112:127], v[52:55], v[220:223], v[112:127]
    ds_read_b64_tr_b16 v[48:49], v5 offset:3136
    ds_read_b64_tr_b16 v[50:51], v5 offset:3904
    s_waitcnt lgkmcnt(6)
    v_mfma_f32_32x32x16_bf16 v[128:143], v[56:59], v[220:223], v[128:143]
    ds_read_b64_tr_b16 v[52:53], v6 offset:3136
    ds_read_b64_tr_b16 v[54:55], v6 offset:3904
    v_mfma_f32_32x32x16_bf16 v[144:159], v[60:63], v[220:223], v[144:159]
    ds_read_b64_tr_b16 v[56:57], v5 offset:3200
    ds_read_b64_tr_b16 v[58:59], v5 offset:3968
    s_waitcnt vmcnt(9) lgkmcnt(6)
    v_mfma_f32_32x32x16_bf16 v[64:79], v[40:43], v[224:227], v[64:79]
    ds_read_b64_tr_b16 v[60:61], v6 offset:3200
    ds_read_b64_tr_b16 v[62:63], v6 offset:3968
    buffer_load_dwordx4 v[168:171], v1, s[28:31], s78 offen offset:2048 sc1
    v_mfma_f32_32x32x16_bf16 v[80:95], v[44:47], v[224:227], v[80:95]
    ds_read_b64_tr_b16 v[40:41], v5 offset:6144
    ds_read_b64_tr_b16 v[42:43], v5 offset:6912
    s_waitcnt lgkmcnt(6)
    v_mfma_f32_32x32x16_bf16 v[96:111], v[48:51], v[224:227], v[96:111]
    ds_read_b64_tr_b16 v[44:45], v6 offset:6144
    ds_read_b64_tr_b16 v[46:47], v6 offset:6912
    v_mfma_f32_32x32x16_bf16 v[112:127], v[52:55], v[224:227], v[112:127]
    ds_read_b64_tr_b16 v[48:49], v5 offset:6208
    ds_read_b64_tr_b16 v[50:51], v5 offset:6976
    s_waitcnt lgkmcnt(6)
    v_mfma_f32_32x32x16_bf16 v[128:143], v[56:59], v[224:227], v[128:143]
    ds_read_b64_tr_b16 v[52:53], v6 offset:6208
    ds_read_b64_tr_b16 v[54:55], v6 offset:6976
    v_mfma_f32_32x32x16_bf16 v[144:159], v[60:63], v[224:227], v[144:159]
    ds_read_b64_tr_b16 v[56:57], v5 offset:6272
    ds_read_b64_tr_b16 v[58:59], v5 offset:7040
    s_waitcnt vmcnt(9) lgkmcnt(6)
    v_mfma_f32_32x32x16_bf16 v[64:79], v[40:43], v[228:231], v[64:79]
    ds_read_b64_tr_b16 v[60:61], v6 offset:6272
    ds_read_b64_tr_b16 v[62:63], v6 offset:7040
    buffer_load_dwordx4 v[172:175], v1, s[28:31], s78 offen offset:3072 sc1
    v_mfma_f32_32x32x16_bf16 v[80:95], v[44:47], v[228:231], v[80:95]
    ds_read_b64_tr_b16 v[40:41], v5 offset:9216
    ds_read_b64_tr_b16 v[42:43], v5 offset:9984
    s_waitcnt lgkmcnt(6)
    v_mfma_f32_32x32x16_bf16 v[96:111], v[48:51], v[228:231], v[96:111]
    ds_read_b64_tr_b16 v[44:45], v6 offset:9216
    ds_read_b64_tr_b16 v[46:47], v6 offset:9984
    v_mfma_f32_32x32x16_bf16 v[112:127], v[52:55], v[228:231], v[112:127]
    ds_read_b64_tr_b16 v[48:49], v5 offset:9280
    ds_read_b64_tr_b16 v[50:51], v5 offset:10048
    s_waitcnt lgkmcnt(6)
    v_mfma_f32_32x32x16_bf16 v[128:143], v[56:59], v[228:231], v[128:143]
    ds_read_b64_tr_b16 v[52:53], v6 offset:9280
    ds_read_b64_tr_b16 v[54:55], v6 offset:10048
    v_mfma_f32_32x32x16_bf16 v[144:159], v[60:63], v[228:231], v[144:159]
    ds_read_b64_tr_b16 v[56:57], v5 offset:9344
    ds_read_b64_tr_b16 v[58:59], v5 offset:10112
    s_waitcnt vmcnt(9) lgkmcnt(6)
    v_mfma_f32_32x32x16_bf16 v[64:79], v[40:43], v[232:235], v[64:79]
    ds_read_b64_tr_b16 v[60:61], v6 offset:9344
    ds_read_b64_tr_b16 v[62:63], v6 offset:10112
    s_add_u32 s78, s78, 4096
    buffer_load_dwordx4 v[176:179], v1, s[28:31], s78 offen offset:0 sc1
    v_mfma_f32_32x32x16_bf16 v[80:95], v[44:47], v[232:235], v[80:95]
    ds_read_b64_tr_b16 v[40:41], v5 offset:12288
    ds_read_b64_tr_b16 v[42:43], v5 offset:13056
    s_waitcnt lgkmcnt(6)
    v_mfma_f32_32x32x16_bf16 v[96:111], v[48:51], v[232:235], v[96:111]
    ds_read_b64_tr_b16 v[44:45], v6 offset:12288
    ds_read_b64_tr_b16 v[46:47], v6 offset:13056
    v_mfma_f32_32x32x16_bf16 v[112:127], v[52:55], v[232:235], v[112:127]
    ds_read_b64_tr_b16 v[48:49], v5 offset:12352
    ds_read_b64_tr_b16 v[50:51], v5 offset:13120
    s_waitcnt lgkmcnt(6)
    v_mfma_f32_32x32x16_bf16 v[128:143], v[56:59], v[232:235], v[128:143]
    ds_read_b64_tr_b16 v[52:53], v6 offset:12352
    ds_read_b64_tr_b16 v[54:55], v6 offset:13120
    v_mfma_f32_32x32x16_bf16 v[144:159], v[60:63], v[232:235], v[144:159]
    ds_read_b64_tr_b16 v[56:57], v5 offset:12416
    ds_read_b64_tr_b16 v[58:59], v5 offset:13184
    s_waitcnt vmcnt(9) lgkmcnt(6)
    v_mfma_f32_32x32x16_bf16 v[64:79], v[40:43], v[236:239], v[64:79]
    ds_read_b64_tr_b16 v[60:61], v6 offset:12416
    ds_read_b64_tr_b16 v[62:63], v6 offset:13184
    buffer_load_dwordx4 v[180:183], v1, s[28:31], s78 offen offset:1024 sc1
    v_mfma_f32_32x32x16_bf16 v[80:95], v[44:47], v[236:239], v[80:95]
    s_add_u32 s57, s56, 294912
    s_and_b32 s57, s57, 0x1ffff
    v_add_u32 v5, s57, v12
    ds_read_b64_tr_b16 v[40:41], v5 offset:0
    ds_read_b64_tr_b16 v[42:43], v5 offset:768
    s_waitcnt lgkmcnt(6)
    v_mfma_f32_32x32x16_bf16 v[96:111], v[48:51], v[236:239], v[96:111]
    s_add_u32 s57, s56, 311296
    s_and_b32 s57, s57, 0x1ffff
    v_add_u32 v6, s57, v12
    ds_read_b64_tr_b16 v[44:45], v6 offset:0
    ds_read_b64_tr_b16 v[46:47], v6 offset:768
    v_mfma_f32_32x32x16_bf16 v[112:127], v[52:55], v[236:239], v[112:127]
    ds_read_b64_tr_b16 v[48:49], v5 offset:64
    ds_read_b64_tr_b16 v[50:51], v5 offset:832
    s_waitcnt lgkmcnt(6)
    v_mfma_f32_32x32x16_bf16 v[128:143], v[56:59], v[236:239], v[128:143]
    ds_read_b64_tr_b16 v[52:53], v6 offset:64
    ds_read_b64_tr_b16 v[54:55], v6 offset:832
    v_mfma_f32_32x32x16_bf16 v[144:159], v[60:63], v[236:239], v[144:159]
    ds_read_b64_tr_b16 v[56:57], v5 offset:128
    ds_read_b64_tr_b16 v[58:59], v5 offset:896
    s_barrier
    s_waitcnt vmcnt(9) lgkmcnt(6)
    v_mfma_f32_32x32x16_bf16 v[64:79], v[40:43], v[240:243], v[64:79]
    ds_read_b64_tr_b16 v[60:61], v6 offset:128
    ds_read_b64_tr_b16 v[62:63], v6 offset:896
    buffer_load_dwordx4 v[184:187], v1, s[28:31], s78 offen offset:2048 sc1
    v_mfma_f32_32x32x16_bf16 v[80:95], v[44:47], v[240:243], v[80:95]
    ds_read_b64_tr_b16 v[40:41], v5 offset:3072
    ds_read_b64_tr_b16 v[42:43], v5 offset:3840
    s_waitcnt lgkmcnt(6)
    v_mfma_f32_32x32x16_bf16 v[96:111], v[48:51], v[240:243], v[96:111]
    ds_read_b64_tr_b16 v[44:45], v6 offset:3072
    ds_read_b64_tr_b16 v[46:47], v6 offset:3840
    v_mfma_f32_32x32x16_bf16 v[112:127], v[52:55], v[240:243], v[112:127]
    ds_read_b64_tr_b16 v[48:49], v5 offset:3136
    ds_read_b64_tr_b16 v[50:51], v5 offset:3904
    s_waitcnt lgkmcnt(6)
    v_mfma_f32_32x32x16_bf16 v[128:143], v[56:59], v[240:243], v[128:143]
    ds_read_b64_tr_b16 v[52:53], v6 offset:3136
    ds_read_b64_tr_b16 v[54:55], v6 offset:3904
    v_mfma_f32_32x32x16_bf16 v[144:159], v[60:63], v[240:243], v[144:159]
    ds_read_b64_tr_b16 v[56:57], v5 offset:3200
    ds_read_b64_tr_b16 v[58:59], v5 offset:3968
    s_waitcnt vmcnt(9) lgkmcnt(6)
    v_mfma_f32_32x32x16_bf16 v[64:79], v[40:43], v[244:247], v[64:79]
    ds_read_b64_tr_b16 v[60:61], v6 offset:3200
    ds_read_b64_tr_b16 v[62:63], v6 offset:3968
    buffer_load_dwordx4 v[188:191], v1, s[28:31], s78 offen offset:3072 sc1
    v_mfma_f32_32x32x16_bf16 v[80:95], v[44:47], v[244:247], v[80:95]
    ds_read_b64_tr_b16 v[40:41], v5 offset:6144
    ds_read_b64_tr_b16 v[42:43], v5 offset:6912
    s_waitcnt lgkmcnt(6)
    v_mfma_f32_32x32x16_bf16 v[96:111], v[48:51], v[244:247], v[96:111]
    ds_read_b64_tr_b16 v[44:45], v6 offset:6144
    ds_read_b64_tr_b16 v[46:47], v6 offset:6912
    v_mfma_f32_32x32x16_bf16 v[112:127], v[52:55], v[244:247], v[112:127]
    ds_read_b64_tr_b16 v[48:49], v5 offset:6208
    ds_read_b64_tr_b16 v[50:51], v5 offset:6976
    s_waitcnt lgkmcnt(6)
    v_mfma_f32_32x32x16_bf16 v[128:143], v[56:59], v[244:247], v[128:143]
    ds_read_b64_tr_b16 v[52:53], v6 offset:6208
    ds_read_b64_tr_b16 v[54:55], v6 offset:6976
    v_mfma_f32_32x32x16_bf16 v[144:159], v[60:63], v[244:247], v[144:159]
    ds_read_b64_tr_b16 v[56:57], v5 offset:6272
    ds_read_b64_tr_b16 v[58:59], v5 offset:7040
    s_waitcnt vmcnt(9) lgkmcnt(6)
    v_mfma_f32_32x32x16_bf16 v[64:79], v[40:43], v[248:251], v[64:79]
    ds_read_b64_tr_b16 v[60:61], v6 offset:6272
    ds_read_b64_tr_b16 v[62:63], v6 offset:7040
    v_mfma_f32_32x32x16_bf16 v[80:95], v[44:47], v[248:251], v[80:95]
    ds_read_b64_tr_b16 v[40:41], v5 offset:9216
    ds_read_b64_tr_b16 v[42:43], v5 offset:9984
    s_waitcnt lgkmcnt(6)
    v_mfma_f32_32x32x16_bf16 v[96:111], v[48:51], v[248:251], v[96:111]
    ds_read_b64_tr_b16 v[44:45], v6 offset:9216
    ds_read_b64_tr_b16 v[46:47], v6 offset:9984
    v_mfma_f32_32x32x16_bf16 v[112:127], v[52:55], v[248:251], v[112:127]
    ds_read_b64_tr_b16 v[48:49], v5 offset:9280
    ds_read_b64_tr_b16 v[50:51], v5 offset:10048
    s_waitcnt lgkmcnt(6)
    v_mfma_f32_32x32x16_bf16 v[128:143], v[56:59], v[248:251], v[128:143]
    ds_read_b64_tr_b16 v[52:53], v6 offset:9280
    ds_read_b64_tr_b16 v[54:55], v6 offset:10048
    v_mfma_f32_32x32x16_bf16 v[144:159], v[60:63], v[248:251], v[144:159]
    ds_read_b64_tr_b16 v[56:57], v5 offset:9344
    ds_read_b64_tr_b16 v[58:59], v5 offset:10112
    s_waitcnt vmcnt(8) lgkmcnt(6)
    v_mfma_f32_32x32x16_bf16 v[64:79], v[40:43], v[252:255], v[64:79]
    ds_read_b64_tr_b16 v[60:61], v6 offset:9344
    ds_read_b64_tr_b16 v[62:63], v6 offset:10112
    v_mfma_f32_32x32x16_bf16 v[80:95], v[44:47], v[252:255], v[80:95]
    ds_read_b64_tr_b16 v[40:41], v5 offset:12288
    ds_read_b64_tr_b16 v[42:43], v5 offset:13056
    s_waitcnt lgkmcnt(6)
    v_mfma_f32_32x32x16_bf16 v[96:111], v[48:51], v[252:255], v[96:111]
    ds_read_b64_tr_b16 v[44:45], v6 offset:12288
    ds_read_b64_tr_b16 v[46:47], v6 offset:13056
    v_mfma_f32_32x32x16_bf16 v[112:127], v[52:55], v[252:255], v[112:127]
    ds_read_b64_tr_b16 v[48:49], v5 offset:12352
    ds_read_b64_tr_b16 v[50:51], v5 offset:13120
    s_waitcnt lgkmcnt(6)
    v_mfma_f32_32x32x16_bf16 v[128:143], v[56:59], v[252:255], v[128:143]
    ds_read_b64_tr_b16 v[52:53], v6 offset:12352
    ds_read_b64_tr_b16 v[54:55], v6 offset:13120
    v_mfma_f32_32x32x16_bf16 v[144:159], v[60:63], v[252:255], v[144:159]
    ds_read_b64_tr_b16 v[56:57], v5 offset:12416
    ds_read_b64_tr_b16 v[58:59], v5 offset:13184
    s_waitcnt vmcnt(7) lgkmcnt(6)
    v_mfma_f32_32x32x16_bf16 v[64:79], v[40:43], v[160:163], v[64:79]
    ds_read_b64_tr_b16 v[60:61], v6 offset:12416
    ds_read_b64_tr_b16 v[62:63], v6 offset:13184
    v_mfma_f32_32x32x16_bf16 v[80:95], v[44:47], v[160:163], v[80:95]
    s_add_u32 s57, s56, 327680
    s_and_b32 s57, s57, 0x1ffff
    v_add_u32 v5, s57, v12
    ds_read_b64_tr_b16 v[40:41], v5 offset:0
    ds_read_b64_tr_b16 v[42:43], v5 offset:768
    s_waitcnt lgkmcnt(6)
    v_mfma_f32_32x32x16_bf16 v[96:111], v[48:51], v[160:163], v[96:111]
    s_add_u32 s57, s56, 344064
    s_and_b32 s57, s57, 0x1ffff
    v_add_u32 v6, s57, v12
    ds_read_b64_tr_b16 v[44:45], v6 offset:0
    ds_read_b64_tr_b16 v[46:47], v6 offset:768
    v_mfma_f32_32x32x16_bf16 v[112:127], v[52:55], v[160:163], v[112:127]
    ds_read_b64_tr_b16 v[48:49], v5 offset:64
    ds_read_b64_tr_b16 v[50:51], v5 offset:832
    s_waitcnt lgkmcnt(6)
    v_mfma_f32_32x32x16_bf16 v[128:143], v[56:59], v[160:163], v[128:143]
    ds_read_b64_tr_b16 v[52:53], v6 offset:64
    ds_read_b64_tr_b16 v[54:55], v6 offset:832
    v_mfma_f32_32x32x16_bf16 v[144:159], v[60:63], v[160:163], v[144:159]
    ds_read_b64_tr_b16 v[56:57], v5 offset:128
    ds_read_b64_tr_b16 v[58:59], v5 offset:896
    s_barrier
    s_waitcnt vmcnt(6) lgkmcnt(6)
    v_mfma_f32_32x32x16_bf16 v[64:79], v[40:43], v[164:167], v[64:79]
    ds_read_b64_tr_b16 v[60:61], v6 offset:128
    ds_read_b64_tr_b16 v[62:63], v6 offset:896
    v_mfma_f32_32x32x16_bf16 v[80:95], v[44:47], v[164:167], v[80:95]
    ds_read_b64_tr_b16 v[40:41], v5 offset:3072
    ds_read_b64_tr_b16 v[42:43], v5 offset:3840
    s_waitcnt lgkmcnt(6)
    v_mfma_f32_32x32x16_bf16 v[96:111], v[48:51], v[164:167], v[96:111]
    ds_read_b64_tr_b16 v[44:45], v6 offset:3072
    ds_read_b64_tr_b16 v[46:47], v6 offset:3840
    v_mfma_f32_32x32x16_bf16 v[112:127], v[52:55], v[164:167], v[112:127]
    ds_read_b64_tr_b16 v[48:49], v5 offset:3136
    ds_read_b64_tr_b16 v[50:51], v5 offset:3904
    s_waitcnt lgkmcnt(6)
    v_mfma_f32_32x32x16_bf16 v[128:143], v[56:59], v[164:167], v[128:143]
    ds_read_b64_tr_b16 v[52:53], v6 offset:3136
    ds_read_b64_tr_b16 v[54:55], v6 offset:3904
    v_mfma_f32_32x32x16_bf16 v[144:159], v[60:63], v[164:167], v[144:159]
    ds_read_b64_tr_b16 v[56:57], v5 offset:3200
    ds_read_b64_tr_b16 v[58:59], v5 offset:3968
    s_waitcnt vmcnt(5) lgkmcnt(6)
    v_mfma_f32_32x32x16_bf16 v[64:79], v[40:43], v[168:171], v[64:79]
    ds_read_b64_tr_b16 v[60:61], v6 offset:3200
    ds_read_b64_tr_b16 v[62:63], v6 offset:3968
    v_mfma_f32_32x32x16_bf16 v[80:95], v[44:47], v[168:171], v[80:95]
    ds_read_b64_tr_b16 v[40:41], v5 offset:6144
    ds_read_b64_tr_b16 v[42:43], v5 offset:6912
    s_waitcnt lgkmcnt(6)
    v_mfma_f32_32x32x16_bf16 v[96:111], v[48:51], v[168:171], v[96:111]
    ds_read_b64_tr_b16 v[44:45], v6 offset:6144
    ds_read_b64_tr_b16 v[46:47], v6 offset:6912
    v_mfma_f32_32x32x16_bf16 v[112:127], v[52:55], v[168:171], v[112:127]
    ds_read_b64_tr_b16 v[48:49], v5 offset:6208
    ds_read_b64_tr_b16 v[50:51], v5 offset:6976
    s_waitcnt lgkmcnt(6)
    v_mfma_f32_32x32x16_bf16 v[128:143], v[56:59], v[168:171], v[128:143]
    ds_read_b64_tr_b16 v[52:53], v6 offset:6208
    ds_read_b64_tr_b16 v[54:55], v6 offset:6976
    v_mfma_f32_32x32x16_bf16 v[144:159], v[60:63], v[168:171], v[144:159]
    ds_read_b64_tr_b16 v[56:57], v5 offset:6272
    ds_read_b64_tr_b16 v[58:59], v5 offset:7040
    s_waitcnt vmcnt(4) lgkmcnt(6)
    v_mfma_f32_32x32x16_bf16 v[64:79], v[40:43], v[172:175], v[64:79]
    ds_read_b64_tr_b16 v[60:61], v6 offset:6272
    ds_read_b64_tr_b16 v[62:63], v6 offset:7040
    v_mfma_f32_32x32x16_bf16 v[80:95], v[44:47], v[172:175], v[80:95]
    ds_read_b64_tr_b16 v[40:41], v5 offset:9216
    ds_read_b64_tr_b16 v[42:43], v5 offset:9984
    s_waitcnt lgkmcnt(6)
    v_mfma_f32_32x32x16_bf16 v[96:111], v[48:51], v[172:175], v[96:111]
    ds_read_b64_tr_b16 v[44:45], v6 offset:9216
    ds_read_b64_tr_b16 v[46:47], v6 offset:9984
    v_mfma_f32_32x32x16_bf16 v[112:127], v[52:55], v[172:175], v[112:127]
    ds_read_b64_tr_b16 v[48:49], v5 offset:9280
    ds_read_b64_tr_b16 v[50:51], v5 offset:10048
    s_waitcnt lgkmcnt(6)
    v_mfma_f32_32x32x16_bf16 v[128:143], v[56:59], v[172:175], v[128:143]
    ds_read_b64_tr_b16 v[52:53], v6 offset:9280
    ds_read_b64_tr_b16 v[54:55], v6 offset:10048
    v_mfma_f32_32x32x16_bf16 v[144:159], v[60:63], v[172:175], v[144:159]
    ds_read_b64_tr_b16 v[56:57], v5 offset:9344
    ds_read_b64_tr_b16 v[58:59], v5 offset:10112
    s_waitcnt vmcnt(3) lgkmcnt(6)
    v_mfma_f32_32x32x16_bf16 v[64:79], v[40:43], v[176:179], v[64:79]
    ds_read_b64_tr_b16 v[60:61], v6 offset:9344
    ds_read_b64_tr_b16 v[62:63], v6 offset:10112
    v_mfma_f32_32x32x16_bf16 v[80:95], v[44:47], v[176:179], v[80:95]
    ds_read_b64_tr_b16 v[40:41], v5 offset:12288
    ds_read_b64_tr_b16 v[42:43], v5 offset:13056
    s_waitcnt lgkmcnt(6)
    v_mfma_f32_32x32x16_bf16 v[96:111], v[48:51], v[176:179], v[96:111]
    ds_read_b64_tr_b16 v[44:45], v6 offset:12288
    ds_read_b64_tr_b16 v[46:47], v6 offset:13056
    v_mfma_f32_32x32x16_bf16 v[112:127], v[52:55], v[176:179], v[112:127]
    ds_read_b64_tr_b16 v[48:49], v5 offset:12352
    ds_read_b64_tr_b16 v[50:51], v5 offset:13120
    s_waitcnt lgkmcnt(6)
    v_mfma_f32_32x32x16_bf16 v[128:143], v[56:59], v[176:179], v[128:143]
    ds_read_b64_tr_b16 v[52:53], v6 offset:12352
    ds_read_b64_tr_b16 v[54:55], v6 offset:13120
    v_mfma_f32_32x32x16_bf16 v[144:159], v[60:63], v[176:179], v[144:159]
    ds_read_b64_tr_b16 v[56:57], v5 offset:12416
    ds_read_b64_tr_b16 v[58:59], v5 offset:13184
    s_waitcnt vmcnt(2) lgkmcnt(6)
    v_mfma_f32_32x32x16_bf16 v[64:79], v[40:43], v[180:183], v[64:79]
    ds_read_b64_tr_b16 v[60:61], v6 offset:12416
    ds_read_b64_tr_b16 v[62:63], v6 offset:13184
    v_mfma_f32_32x32x16_bf16 v[80:95], v[44:47], v[180:183], v[80:95]
    s_add_u32 s57, s56, 360448
    s_and_b32 s57, s57, 0x1ffff
    v_add_u32 v5, s57, v12
    ds_read_b64_tr_b16 v[40:41], v5 offset:0
    ds_read_b64_tr_b16 v[42:43], v5 offset:768
    s_waitcnt lgkmcnt(6)
    v_mfma_f32_32x32x16_bf16 v[96:111], v[48:51], v[180:183], v[96:111]
    s_add_u32 s57, s56, 376832
    s_and_b32 s57, s57, 0x1ffff
    v_add_u32 v6, s57, v12
    ds_read_b64_tr_b16 v[44:45], v6 offset:0
    ds_read_b64_tr_b16 v[46:47], v6 offset:768
    v_mfma_f32_32x32x16_bf16 v[112:127], v[52:55], v[180:183], v[112:127]
    ds_read_b64_tr_b16 v[48:49], v5 offset:64
    ds_read_b64_tr_b16 v[50:51], v5 offset:832
    s_waitcnt lgkmcnt(6)
    v_mfma_f32_32x32x16_bf16 v[128:143], v[56:59], v[180:183], v[128:143]
    ds_read_b64_tr_b16 v[52:53], v6 offset:64
    ds_read_b64_tr_b16 v[54:55], v6 offset:832
    v_mfma_f32_32x32x16_bf16 v[144:159], v[60:63], v[180:183], v[144:159]
    ds_read_b64_tr_b16 v[56:57], v5 offset:128
    ds_read_b64_tr_b16 v[58:59], v5 offset:896
    s_barrier
    s_waitcnt vmcnt(1) lgkmcnt(6)
    v_mfma_f32_32x32x16_bf16 v[64:79], v[40:43], v[184:187], v[64:79]
    ds_read_b64_tr_b16 v[60:61], v6 offset:128
    ds_read_b64_tr_b16 v[62:63], v6 offset:896
    v_mfma_f32_32x32x16_bf16 v[80:95], v[44:47], v[184:187], v[80:95]
    ds_read_b64_tr_b16 v[40:41], v5 offset:3072
    ds_read_b64_tr_b16 v[42:43], v5 offset:3840
    s_waitcnt lgkmcnt(6)
    v_mfma_f32_32x32x16_bf16 v[96:111], v[48:51], v[184:187], v[96:111]
    ds_read_b64_tr_b16 v[44:45], v6 offset:3072
    ds_read_b64_tr_b16 v[46:47], v6 offset:3840
    v_mfma_f32_32x32x16_bf16 v[112:127], v[52:55], v[184:187], v[112:127]
    ds_read_b64_tr_b16 v[48:49], v5 offset:3136
    ds_read_b64_tr_b16 v[50:51], v5 offset:3904
    s_waitcnt lgkmcnt(6)
    v_mfma_f32_32x32x16_bf16 v[128:143], v[56:59], v[184:187], v[128:143]
    ds_read_b64_tr_b16 v[52:53], v6 offset:3136
    ds_read_b64_tr_b16 v[54:55], v6 offset:3904
    v_mfma_f32_32x32x16_bf16 v[144:159], v[60:63], v[184:187], v[144:159]
    ds_read_b64_tr_b16 v[56:57], v5 offset:3200
    ds_read_b64_tr_b16 v[58:59], v5 offset:3968
    s_waitcnt vmcnt(0) lgkmcnt(6)
    v_mfma_f32_32x32x16_bf16 v[64:79], v[40:43], v[188:191], v[64:79]
    ds_read_b64_tr_b16 v[60:61], v6 offset:3200
    ds_read_b64_tr_b16 v[62:63], v6 offset:3968
    v_mfma_f32_32x32x16_bf16 v[80:95], v[44:47], v[188:191], v[80:95]
    s_waitcnt lgkmcnt(4)
    v_mfma_f32_32x32x16_bf16 v[96:111], v[48:51], v[188:191], v[96:111]
    v_mfma_f32_32x32x16_bf16 v[112:127], v[52:55], v[188:191], v[112:127]
    s_waitcnt lgkmcnt(0)
    v_mfma_f32_32x32x16_bf16 v[128:143], v[56:59], v[188:191], v[128:143]
    v_mfma_f32_32x32x16_bf16 v[144:159], v[60:63], v[188:191], v[144:159]
    s_barrier
    ds_read_b64 v[32:33], v15 offset:1536
    ds_read_b64 v[36:37], v15 offset:2048
    s_waitcnt lgkmcnt(1)
    v_mfma_f32_32x32x16_bf16 v[64:79], v[32:35], v[28:31], v[64:79]
    s_waitcnt lgkmcnt(0)
    v_mfma_f32_32x32x16_bf16 v[80:95], v[36:39], v[28:31], v[80:95]
    ds_read_b64 v[32:33], v15 offset:2560
    ds_read_b64 v[36:37], v15 offset:3072
    s_waitcnt lgkmcnt(1)
    v_mfma_f32_32x32x16_bf16 v[96:111], v[32:35], v[28:31], v[96:111]
    s_waitcnt lgkmcnt(0)
    v_mfma_f32_32x32x16_bf16 v[112:127], v[36:39], v[28:31], v[112:127]
    ds_read_b64 v[32:33], v15 offset:3584
    ds_read_b64 v[36:37], v15 offset:4096
    s_waitcnt lgkmcnt(1)
    v_mfma_f32_32x32x16_bf16 v[128:143], v[32:35], v[28:31], v[128:143]
    s_waitcnt lgkmcnt(0)
    v_mfma_f32_32x32x16_bf16 v[144:159], v[36:39], v[28:31], v[144:159]
    v_pk_mul_f32 v[16:17], v[64:65], v[64:65]
    v_pk_mul_f32 v[18:19], v[66:67], v[66:67]
    v_pk_mul_f32 v[20:21], v[68:69], v[68:69]
    v_pk_mul_f32 v[22:23], v[70:71], v[70:71]
    v_pk_fma_f32 v[16:17], v[16:17], v[8:9], v[8:9] op_sel:[0,1,0] op_sel_hi:[1,1,0]
    v_pk_fma_f32 v[18:19], v[18:19], v[8:9], v[8:9] op_sel:[0,1,0] op_sel_hi:[1,1,0]
    v_pk_fma_f32 v[20:21], v[20:21], v[8:9], v[8:9] op_sel:[0,1,0] op_sel_hi:[1,1,0]
    v_pk_fma_f32 v[22:23], v[22:23], v[8:9], v[8:9] op_sel:[0,1,0] op_sel_hi:[1,1,0]
    v_pk_mul_f32 v[16:17], v[16:17], v[64:65]
    v_pk_mul_f32 v[18:19], v[18:19], v[66:67]
    v_pk_mul_f32 v[20:21], v[20:21], v[68:69]
    v_pk_mul_f32 v[22:23], v[22:23], v[70:71]
    v_exp_f32 v16, v16
    v_exp_f32 v17, v17
    v_exp_f32 v18, v18
    v_exp_f32 v19, v19
    v_exp_f32 v20, v20
    v_exp_f32 v21, v21
    v_exp_f32 v22, v22
    v_exp_f32 v23, v23
    v_pk_mul_f32 v[80:81], v[80:81], v[64:65]
    v_pk_mul_f32 v[82:83], v[82:83], v[66:67]
    v_pk_mul_f32 v[84:85], v[84:85], v[68:69]
    v_pk_mul_f32 v[86:87], v[86:87], v[70:71]
    v_pk_fma_f32 v[16:17], v[16:17], v[10:11], v[10:11] op_sel:[0,0,0] op_sel_hi:[1,0,0]
    v_pk_fma_f32 v[18:19], v[18:19], v[10:11], v[10:11] op_sel:[0,0,0] op_sel_hi:[1,0,0]
    v_pk_fma_f32 v[20:21], v[20:21], v[10:11], v[10:11] op_sel:[0,0,0] op_sel_hi:[1,0,0]
    v_pk_fma_f32 v[22:23], v[22:23], v[10:11], v[10:11] op_sel:[0,0,0] op_sel_hi:[1,0,0]
    v_rcp_f32 v16, v16
    v_rcp_f32 v17, v17
    v_rcp_f32 v18, v18
    v_rcp_f32 v19, v19
    v_rcp_f32 v20, v20
    v_rcp_f32 v21, v21
    v_rcp_f32 v22, v22
    v_rcp_f32 v23, v23
    v_pk_mul_f32 v[80:81], v[80:81], v[16:17]
    v_pk_mul_f32 v[82:83], v[82:83], v[18:19]
    v_pk_mul_f32 v[84:85], v[84:85], v[20:21]
    v_pk_mul_f32 v[86:87], v[86:87], v[22:23]
    v_pk_mul_f32 v[16:17], v[72:73], v[72:73]
    v_pk_mul_f32 v[18:19], v[74:75], v[74:75]
    v_pk_mul_f32 v[20:21], v[76:77], v[76:77]
    v_pk_mul_f32 v[22:23], v[78:79], v[78:79]
    v_pk_fma_f32 v[16:17], v[16:17], v[8:9], v[8:9] op_sel:[0,1,0] op_sel_hi:[1,1,0]
    v_pk_fma_f32 v[18:19], v[18:19], v[8:9], v[8:9] op_sel:[0,1,0] op_sel_hi:[1,1,0]
    v_pk_fma_f32 v[20:21], v[20:21], v[8:9], v[8:9] op_sel:[0,1,0] op_sel_hi:[1,1,0]
    v_pk_fma_f32 v[22:23], v[22:23], v[8:9], v[8:9] op_sel:[0,1,0] op_sel_hi:[1,1,0]
    v_pk_mul_f32 v[16:17], v[16:17], v[72:73]
    v_pk_mul_f32 v[18:19], v[18:19], v[74:75]
    v_pk_mul_f32 v[20:21], v[20:21], v[76:77]
    v_pk_mul_f32 v[22:23], v[22:23], v[78:79]
    v_exp_f32 v16, v16
    v_exp_f32 v17, v17
    v_exp_f32 v18, v18
    v_exp_f32 v19, v19
    v_exp_f32 v20, v20
    v_exp_f32 v21, v21
    v_exp_f32 v22, v22
    v_exp_f32 v23, v23
    v_pk_mul_f32 v[88:89], v[88:89], v[72:73]
    v_pk_mul_f32 v[90:91], v[90:91], v[74:75]
    v_pk_mul_f32 v[92:93], v[92:93], v[76:77]
    v_pk_mul_f32 v[94:95], v[94:95], v[78:79]
    v_pk_fma_f32 v[16:17], v[16:17], v[10:11], v[10:11] op_sel:[0,0,0] op_sel_hi:[1,0,0]
    v_pk_fma_f32 v[18:19], v[18:19], v[10:11], v[10:11] op_sel:[0,0,0] op_sel_hi:[1,0,0]
    v_pk_fma_f32 v[20:21], v[20:21], v[10:11], v[10:11] op_sel:[0,0,0] op_sel_hi:[1,0,0]
    v_pk_fma_f32 v[22:23], v[22:23], v[10:11], v[10:11] op_sel:[0,0,0] op_sel_hi:[1,0,0]
    v_rcp_f32 v16, v16
    v_rcp_f32 v17, v17
    v_rcp_f32 v18, v18
    v_rcp_f32 v19, v19
    v_rcp_f32 v20, v20
    v_rcp_f32 v21, v21
    v_rcp_f32 v22, v22
    v_rcp_f32 v23, v23
    v_pk_mul_f32 v[88:89], v[88:89], v[16:17]
    v_pk_mul_f32 v[90:91], v[90:91], v[18:19]
    v_pk_mul_f32 v[92:93], v[92:93], v[20:21]
    v_pk_mul_f32 v[94:95], v[94:95], v[22:23]
    v_cvt_pk_bf16_f32 v64, v80, v81
    v_cvt_pk_bf16_f32 v65, v82, v83
    v_cvt_pk_bf16_f32 v66, v84, v85
    v_cvt_pk_bf16_f32 v67, v86, v87
    v_cvt_pk_bf16_f32 v68, v88, v89
    v_cvt_pk_bf16_f32 v69, v90, v91
    v_cvt_pk_bf16_f32 v70, v92, v93
    v_cvt_pk_bf16_f32 v71, v94, v95
    v_permlane32_swap_b32 v64, v66
    v_permlane32_swap_b32 v65, v67
    v_permlane32_swap_b32 v68, v70
    v_permlane32_swap_b32 v69, v71
    s_add_u32 s57, s84, 0
    buffer_store_dwordx4 v[64:67], v1, s[32:35], s57 offen offset:0
    buffer_store_dwordx4 v[64:67], v1, s[36:39], s57 offen offset:0 sc1
    buffer_store_dwordx4 v[68:71], v1, s[32:35], s57 offen offset:1024
    buffer_store_dwordx4 v[68:71], v1, s[36:39], s57 offen offset:1024 sc1
    v_pk_mul_f32 v[16:17], v[96:97], v[96:97]
    v_pk_mul_f32 v[18:19], v[98:99], v[98:99]
    v_pk_mul_f32 v[20:21], v[100:101], v[100:101]
    v_pk_mul_f32 v[22:23], v[102:103], v[102:103]
    v_pk_fma_f32 v[16:17], v[16:17], v[8:9], v[8:9] op_sel:[0,1,0] op_sel_hi:[1,1,0]
    v_pk_fma_f32 v[18:19], v[18:19], v[8:9], v[8:9] op_sel:[0,1,0] op_sel_hi:[1,1,0]
    v_pk_fma_f32 v[20:21], v[20:21], v[8:9], v[8:9] op_sel:[0,1,0] op_sel_hi:[1,1,0]
    v_pk_fma_f32 v[22:23], v[22:23], v[8:9], v[8:9] op_sel:[0,1,0] op_sel_hi:[1,1,0]
    v_pk_mul_f32 v[16:17], v[16:17], v[96:97]
    v_pk_mul_f32 v[18:19], v[18:19], v[98:99]
    v_pk_mul_f32 v[20:21], v[20:21], v[100:101]
    v_pk_mul_f32 v[22:23], v[22:23], v[102:103]
    v_exp_f32 v16, v16
    v_exp_f32 v17, v17
    v_exp_f32 v18, v18
    v_exp_f32 v19, v19
    v_exp_f32 v20, v20
    v_exp_f32 v21, v21
    v_exp_f32 v22, v22
    v_exp_f32 v23, v23
    v_pk_mul_f32 v[112:113], v[112:113], v[96:97]
    v_pk_mul_f32 v[114:115], v[114:115], v[98:99]
    v_pk_mul_f32 v[116:117], v[116:117], v[100:101]
    v_pk_mul_f32 v[118:119], v[118:119], v[102:103]
    v_pk_fma_f32 v[16:17], v[16:17], v[10:11], v[10:11] op_sel:[0,0,0] op_sel_hi:[1,0,0]
    v_pk_fma_f32 v[18:19], v[18:19], v[10:11], v[10:11] op_sel:[0,0,0] op_sel_hi:[1,0,0]
    v_pk_fma_f32 v[20:21], v[20:21], v[10:11], v[10:11] op_sel:[0,0,0] op_sel_hi:[1,0,0]
    v_pk_fma_f32 v[22:23], v[22:23], v[10:11], v[10:11] op_sel:[0,0,0] op_sel_hi:[1,0,0]
    v_rcp_f32 v16, v16
    v_rcp_f32 v17, v17
    v_rcp_f32 v18, v18
    v_rcp_f32 v19, v19
    v_rcp_f32 v20, v20
    v_rcp_f32 v21, v21
    v_rcp_f32 v22, v22
    v_rcp_f32 v23, v23
    v_pk_mul_f32 v[112:113], v[112:113], v[16:17]
    v_pk_mul_f32 v[114:115], v[114:115], v[18:19]
    v_pk_mul_f32 v[116:117], v[116:117], v[20:21]
    v_pk_mul_f32 v[118:119], v[118:119], v[22:23]
    v_pk_mul_f32 v[16:17], v[104:105], v[104:105]
    v_pk_mul_f32 v[18:19], v[106:107], v[106:107]
    v_pk_mul_f32 v[20:21], v[108:109], v[108:109]
    v_pk_mul_f32 v[22:23], v[110:111], v[110:111]
    v_pk_fma_f32 v[16:17], v[16:17], v[8:9], v[8:9] op_sel:[0,1,0] op_sel_hi:[1,1,0]
    v_pk_fma_f32 v[18:19], v[18:19], v[8:9], v[8:9] op_sel:[0,1,0] op_sel_hi:[1,1,0]
    v_pk_fma_f32 v[20:21], v[20:21], v[8:9], v[8:9] op_sel:[0,1,0] op_sel_hi:[1,1,0]
    v_pk_fma_f32 v[22:23], v[22:23], v[8:9], v[8:9] op_sel:[0,1,0] op_sel_hi:[1,1,0]
    v_pk_mul_f32 v[16:17], v[16:17], v[104:105]
    v_pk_mul_f32 v[18:19], v[18:19], v[106:107]
    v_pk_mul_f32 v[20:21], v[20:21], v[108:109]
    v_pk_mul_f32 v[22:23], v[22:23], v[110:111]
    v_exp_f32 v16, v16
    v_exp_f32 v17, v17
    v_exp_f32 v18, v18
    v_exp_f32 v19, v19
    v_exp_f32 v20, v20
    v_exp_f32 v21, v21
    v_exp_f32 v22, v22
    v_exp_f32 v23, v23
    v_pk_mul_f32 v[120:121], v[120:121], v[104:105]
    v_pk_mul_f32 v[122:123], v[122:123], v[106:107]
    v_pk_mul_f32 v[124:125], v[124:125], v[108:109]
    v_pk_mul_f32 v[126:127], v[126:127], v[110:111]
    v_pk_fma_f32 v[16:17], v[16:17], v[10:11], v[10:11] op_sel:[0,0,0] op_sel_hi:[1,0,0]
    v_pk_fma_f32 v[18:19], v[18:19], v[10:11], v[10:11] op_sel:[0,0,0] op_sel_hi:[1,0,0]
    v_pk_fma_f32 v[20:21], v[20:21], v[10:11], v[10:11] op_sel:[0,0,0] op_sel_hi:[1,0,0]
    v_pk_fma_f32 v[22:23], v[22:23], v[10:11], v[10:11] op_sel:[0,0,0] op_sel_hi:[1,0,0]
    v_rcp_f32 v16, v16
    v_rcp_f32 v17, v17
    v_rcp_f32 v18, v18
    v_rcp_f32 v19, v19
    v_rcp_f32 v20, v20
    v_rcp_f32 v21, v21
    v_rcp_f32 v22, v22
    v_rcp_f32 v23, v23
    v_pk_mul_f32 v[120:121], v[120:121], v[16:17]
    v_pk_mul_f32 v[122:123], v[122:123], v[18:19]
    v_pk_mul_f32 v[124:125], v[124:125], v[20:21]
    v_pk_mul_f32 v[126:127], v[126:127], v[22:23]
    v_cvt_pk_bf16_f32 v96, v112, v113
    v_cvt_pk_bf16_f32 v97, v114, v115
    v_cvt_pk_bf16_f32 v98, v116, v117
    v_cvt_pk_bf16_f32 v99, v118, v119
    v_cvt_pk_bf16_f32 v100, v120, v121
    v_cvt_pk_bf16_f32 v101, v122, v123
    v_cvt_pk_bf16_f32 v102, v124, v125
    v_cvt_pk_bf16_f32 v103, v126, v127
    v_permlane32_swap_b32 v96, v98
    v_permlane32_swap_b32 v97, v99
    v_permlane32_swap_b32 v100, v102
    v_permlane32_swap_b32 v101, v103
    s_add_u32 s57, s84, 2048
    buffer_store_dwordx4 v[96:99], v1, s[32:35], s57 offen offset:0
    buffer_store_dwordx4 v[96:99], v1, s[36:39], s57 offen offset:0 sc1
    buffer_store_dwordx4 v[100:103], v1, s[32:35], s57 offen offset:1024
    buffer_store_dwordx4 v[100:103], v1, s[36:39], s57 offen offset:1024 sc1
    v_pk_mul_f32 v[16:17], v[128:129], v[128:129]
    v_pk_mul_f32 v[18:19], v[130:131], v[130:131]
    v_pk_mul_f32 v[20:21], v[132:133], v[132:133]
    v_pk_mul_f32 v[22:23], v[134:135], v[134:135]
    v_pk_fma_f32 v[16:17], v[16:17], v[8:9], v[8:9] op_sel:[0,1,0] op_sel_hi:[1,1,0]
    v_pk_fma_f32 v[18:19], v[18:19], v[8:9], v[8:9] op_sel:[0,1,0] op_sel_hi:[1,1,0]
    v_pk_fma_f32 v[20:21], v[20:21], v[8:9], v[8:9] op_sel:[0,1,0] op_sel_hi:[1,1,0]
    v_pk_fma_f32 v[22:23], v[22:23], v[8:9], v[8:9] op_sel:[0,1,0] op_sel_hi:[1,1,0]
    v_pk_mul_f32 v[16:17], v[16:17], v[128:129]
    v_pk_mul_f32 v[18:19], v[18:19], v[130:131]
    v_pk_mul_f32 v[20:21], v[20:21], v[132:133]
    v_pk_mul_f32 v[22:23], v[22:23], v[134:135]
    v_exp_f32 v16, v16
    v_exp_f32 v17, v17
    v_exp_f32 v18, v18
    v_exp_f32 v19, v19
    v_exp_f32 v20, v20
    v_exp_f32 v21, v21
    v_exp_f32 v22, v22
    v_exp_f32 v23, v23
    v_pk_mul_f32 v[144:145], v[144:145], v[128:129]
    v_pk_mul_f32 v[146:147], v[146:147], v[130:131]
    v_pk_mul_f32 v[148:149], v[148:149], v[132:133]
    v_pk_mul_f32 v[150:151], v[150:151], v[134:135]
    v_pk_fma_f32 v[16:17], v[16:17], v[10:11], v[10:11] op_sel:[0,0,0] op_sel_hi:[1,0,0]
    v_pk_fma_f32 v[18:19], v[18:19], v[10:11], v[10:11] op_sel:[0,0,0] op_sel_hi:[1,0,0]
    v_pk_fma_f32 v[20:21], v[20:21], v[10:11], v[10:11] op_sel:[0,0,0] op_sel_hi:[1,0,0]
    v_pk_fma_f32 v[22:23], v[22:23], v[10:11], v[10:11] op_sel:[0,0,0] op_sel_hi:[1,0,0]
    v_rcp_f32 v16, v16
    v_rcp_f32 v17, v17
    v_rcp_f32 v18, v18
    v_rcp_f32 v19, v19
    v_rcp_f32 v20, v20
    v_rcp_f32 v21, v21
    v_rcp_f32 v22, v22
    v_rcp_f32 v23, v23
    v_pk_mul_f32 v[144:145], v[144:145], v[16:17]
    v_pk_mul_f32 v[146:147], v[146:147], v[18:19]
    v_pk_mul_f32 v[148:149], v[148:149], v[20:21]
    v_pk_mul_f32 v[150:151], v[150:151], v[22:23]
    v_pk_mul_f32 v[16:17], v[136:137], v[136:137]
    v_pk_mul_f32 v[18:19], v[138:139], v[138:139]
    v_pk_mul_f32 v[20:21], v[140:141], v[140:141]
    v_pk_mul_f32 v[22:23], v[142:143], v[142:143]
    v_pk_fma_f32 v[16:17], v[16:17], v[8:9], v[8:9] op_sel:[0,1,0] op_sel_hi:[1,1,0]
    v_pk_fma_f32 v[18:19], v[18:19], v[8:9], v[8:9] op_sel:[0,1,0] op_sel_hi:[1,1,0]
    v_pk_fma_f32 v[20:21], v[20:21], v[8:9], v[8:9] op_sel:[0,1,0] op_sel_hi:[1,1,0]
    v_pk_fma_f32 v[22:23], v[22:23], v[8:9], v[8:9] op_sel:[0,1,0] op_sel_hi:[1,1,0]
    v_pk_mul_f32 v[16:17], v[16:17], v[136:137]
    v_pk_mul_f32 v[18:19], v[18:19], v[138:139]
    v_pk_mul_f32 v[20:21], v[20:21], v[140:141]
    v_pk_mul_f32 v[22:23], v[22:23], v[142:143]
    v_exp_f32 v16, v16
    v_exp_f32 v17, v17
    v_exp_f32 v18, v18
    v_exp_f32 v19, v19
    v_exp_f32 v20, v20
    v_exp_f32 v21, v21
    v_exp_f32 v22, v22
    v_exp_f32 v23, v23
    v_pk_mul_f32 v[152:153], v[152:153], v[136:137]
    v_pk_mul_f32 v[154:155], v[154:155], v[138:139]
    v_pk_mul_f32 v[156:157], v[156:157], v[140:141]
    v_pk_mul_f32 v[158:159], v[158:159], v[142:143]
    v_pk_fma_f32 v[16:17], v[16:17], v[10:11], v[10:11] op_sel:[0,0,0] op_sel_hi:[1,0,0]
    v_pk_fma_f32 v[18:19], v[18:19], v[10:11], v[10:11] op_sel:[0,0,0] op_sel_hi:[1,0,0]
    v_pk_fma_f32 v[20:21], v[20:21], v[10:11], v[10:11] op_sel:[0,0,0] op_sel_hi:[1,0,0]
    v_pk_fma_f32 v[22:23], v[22:23], v[10:11], v[10:11] op_sel:[0,0,0] op_sel_hi:[1,0,0]
    v_rcp_f32 v16, v16
    v_rcp_f32 v17, v17
    v_rcp_f32 v18, v18
    v_rcp_f32 v19, v19
    v_rcp_f32 v20, v20
    v_rcp_f32 v21, v21
    v_rcp_f32 v22, v22
    v_rcp_f32 v23, v23
    v_pk_mul_f32 v[152:153], v[152:153], v[16:17]
    v_pk_mul_f32 v[154:155], v[154:155], v[18:19]
    v_pk_mul_f32 v[156:157], v[156:157], v[20:21]
    v_pk_mul_f32 v[158:159], v[158:159], v[22:23]
    v_cvt_pk_bf16_f32 v128, v144, v145
    v_cvt_pk_bf16_f32 v129, v146, v147
    v_cvt_pk_bf16_f32 v130, v148, v149
    v_cvt_pk_bf16_f32 v131, v150, v151
    v_cvt_pk_bf16_f32 v132, v152, v153
    v_cvt_pk_bf16_f32 v133, v154, v155
    v_cvt_pk_bf16_f32 v134, v156, v157
    v_cvt_pk_bf16_f32 v135, v158, v159
    v_permlane32_swap_b32 v128, v130
    v_permlane32_swap_b32 v129, v131
    v_permlane32_swap_b32 v132, v134
    v_permlane32_swap_b32 v133, v135
    s_add_u32 s57, s84, 4096
    buffer_store_dwordx4 v[128:131], v1, s[32:35], s57 offen offset:0
    buffer_store_dwordx4 v[128:131], v1, s[36:39], s57 offen offset:0 sc1
    buffer_store_dwordx4 v[132:135], v1, s[32:35], s57 offen offset:1024
    buffer_store_dwordx4 v[132:135], v1, s[36:39], s57 offen offset:1024 sc1
    s_add_u32 s49, s49, 1
    s_waitcnt vmcnt(0)
    s_add_u32 s57, s23, s49
    v_mov_b32 v7, s57
    s_mov_b64 exec, 1
    buffer_store_dword v7, v4, s[32:35], 0 offen
    buffer_store_dword v7, v4, s[36:39], 0 offen sc1
    s_mov_b64 exec, -1
    s_mul_i32 s87, s51, 6144
    v_lshrrev_b32 v12, 5, v0
    v_lshlrev_b32 v12, 10, v12
    v_bfe_u32 v13, v0, 2, 2
    v_lshl_add_u32 v12, v13, 7, v12
    v_bfe_u32 v13, v0, 3, 1
    v_lshl_add_u32 v12, v13, 6, v12
    v_bfe_u32 v13, v0, 4, 1
    v_lshl_add_u32 v12, v13, 5, v12
    v_and_b32 v13, 3, v0
    v_lshl_add_u32 v12, v13, 3, v12
    s_lshl_b32 s57, s51, 6
    v_xor_b32 v12, s57, v12
    v_xor_b32 v13, 64, v12
    v_and_b32 v7, 31, v0
    v_lshlrev_b32 v7, 4, v7
    v_lshrrev_b32 v8, 5, v0
    v_lshl_add_u32 v7, v8, 3, v7
    s_lshl_b32 s57, s55, 15
    s_lshl_b32 s58, s53, 12
    s_add_u32 s57, s57, s58
    s_lshl_b32 s58, s51, 11
    s_add_u32 s80, s57, s58
    s_add_u32 s57, s80, s73
    buffer_load_dwordx2 v[16:17], v7, s[28:31], s57 offen offset:0 sc1
    buffer_load_dwordx2 v[18:19], v7, s[28:31], s57 offen offset:512 sc1
    buffer_load_dwordx2 v[20:21], v7, s[28:31], s57 offen offset:1024 sc1
    buffer_load_dwordx2 v[22:23], v7, s[28:31], s57 offen offset:1536 sc1
    s_waitcnt vmcnt(0)
    v_lshlrev_b32 v64, 16, v16
    v_and_b32 v65, 0xffff0000, v16
    v_lshlrev_b32 v66, 16, v17
    v_and_b32 v67, 0xffff0000, v17
    v_lshlrev_b32 v68, 16, v18
    v_and_b32 v69, 0xffff0000, v18
    v_lshlrev_b32 v70, 16, v19
    v_and_b32 v71, 0xffff0000, v19
    v_lshlrev_b32 v72, 16, v20
    v_and_b32 v73, 0xffff0000, v20
    v_lshlrev_b32 v74, 16, v21
    v_and_b32 v75, 0xffff0000, v21
    v_lshlrev_b32 v76, 16, v22
    v_and_b32 v77, 0xffff0000, v22
    v_lshlrev_b32 v78, 16, v23
    v_and_b32 v79, 0xffff0000, v23
    s_lshl_b32 s57, s52, 1
    s_add_u32 s57, s57, s50
    s_mov_b32 s58, 0x11111111
    s_lshl_b32 s58, s58, s57
    s_lshl_b32 s59, 1, s57
    s_cmp_eq_u32 s51, 0
    s_cselect_b32 s64, s58, 0
    s_cselect_b32 s65, s59, s58
    s_add_u32 s68, s23, s49
    s_mov_b32 s69, 0
Lpoll_C_19:
    buffer_load_dword v7, v3, s[28:31], 0 offen sc1
    s_add_u32 s69, s69, 1
    s_waitcnt vmcnt(0)
    v_subrev_u32 v7, s68, v7
    v_cmp_gt_u32 vcc, 16, v7
    s_nop 1
    s_and_b64 s[66:67], vcc, s[64:65]
    s_cmp_eq_u64 s[66:67], s[64:65]
    s_cbranch_scc1 Lpdone_C_20
    s_cmp_lt_u32 s69, 262144
    s_cbranch_scc1 Lpoll_C_19
Lpdone_C_20:
    s_nop 1
    s_mul_i32 s78, s55, 88064
    s_add_u32 s78, s78, s75
    s_mul_i32 s57, s51, 44032
    s_add_u32 s78, s78, s57
    buffer_load_dwordx4 v[128:131], v1, s[28:31], s78 offen offset:0 sc1
    buffer_load_dwordx4 v[132:135], v1, s[28:31], s78 offen offset:1024 sc1
    buffer_load_dwordx4 v[136:139], v1, s[28:31], s78 offen offset:2048 sc1
    buffer_load_dwordx4 v[140:143], v1, s[28:31], s78 offen offset:3072 sc1
    s_add_u32 s78, s78, 4096
    buffer_load_dwordx4 v[144:147], v1, s[28:31], s78 offen offset:0 sc1
    buffer_load_dwordx4 v[148:151], v1, s[28:31], s78 offen offset:1024 sc1
    s_barrier
    s_add_u32 s57, s56, 393216
    s_add_u32 s57, s57, s83
    s_and_b32 s57, s57, 0x1ffff
    v_add_u32 v5, s57, v12
    ds_read_b64_tr_b16 v[40:41], v5 offset:0
    ds_read_b64_tr_b16 v[42:43], v5 offset:512
    s_add_u32 s57, s56, 393216
    s_add_u32 s57, s57, s83
    s_and_b32 s57, s57, 0x1ffff
    v_add_u32 v6, s57, v13
    ds_read_b64_tr_b16 v[44:45], v6 offset:0
    ds_read_b64_tr_b16 v[46:47], v6 offset:512
    ds_read_b64_tr_b16 v[48:49], v5 offset:2048
    ds_read_b64_tr_b16 v[50:51], v5 offset:2560
    ds_read_b64_tr_b16 v[52:53], v6 offset:2048
    ds_read_b64_tr_b16 v[54:55], v6 offset:2560
    ds_read_b64_tr_b16 v[56:57], v5 offset:4096
    ds_read_b64_tr_b16 v[58:59], v5 offset:4608
    s_waitcnt vmcnt(5) lgkmcnt(6)
    v_mfma_f32_32x32x16_bf16 v[64:79], v[40:43], v[128:131], v[64:79]
    ds_read_b64_tr_b16 v[60:61], v6 offset:4096
    ds_read_b64_tr_b16 v[62:63], v6 offset:4608
    buffer_load_dwordx4 v[152:155], v1, s[28:31], s78 offen offset:2048 sc1
    v_mfma_f32_32x32x16_bf16 v[80:95], v[44:47], v[128:131], 0
    ds_read_b64_tr_b16 v[40:41], v5 offset:6144
    ds_read_b64_tr_b16 v[42:43], v5 offset:6656
    buffer_load_dwordx4 v[156:159], v1, s[28:31], s78 offen offset:3072 sc1
    s_waitcnt vmcnt(6) lgkmcnt(6)
    v_mfma_f32_32x32x16_bf16 v[64:79], v[48:51], v[132:135], v[64:79]
    ds_read_b64_tr_b16 v[44:45], v6 offset:6144
    ds_read_b64_tr_b16 v[46:47], v6 offset:6656
    s_add_u32 s78, s78, 4096
    buffer_load_dwordx4 v[160:163], v1, s[28:31], s78 offen offset:0 sc1
    v_mfma_f32_32x32x16_bf16 v[80:95], v[52:55], v[132:135], v[80:95]
    ds_read_b64_tr_b16 v[48:49], v5 offset:8192
    ds_read_b64_tr_b16 v[50:51], v5 offset:8704
    buffer_load_dwordx4 v[164:167], v1, s[28:31], s78 offen offset:1024 sc1
    s_waitcnt vmcnt(7) lgkmcnt(6)
    v_mfma_f32_32x32x16_bf16 v[64:79], v[56:59], v[136:139], v[64:79]
    ds_read_b64_tr_b16 v[52:53], v6 offset:8192
    ds_read_b64_tr_b16 v[54:55], v6 offset:8704
    buffer_load_dwordx4 v[168:171], v1, s[28:31], s78 offen offset:2048 sc1
    v_mfma_f32_32x32x16_bf16 v[80:95], v[60:63], v[136:139], v[80:95]
    ds_read_b64_tr_b16 v[56:57], v5 offset:10240
    ds_read_b64_tr_b16 v[58:59], v5 offset:10752
    buffer_load_dwordx4 v[172:175], v1, s[28:31], s78 offen offset:3072 sc1
    s_waitcnt vmcnt(8) lgkmcnt(6)
    v_mfma_f32_32x32x16_bf16 v[64:79], v[40:43], v[140:143], v[64:79]
    ds_read_b64_tr_b16 v[60:61], v6 offset:10240
    ds_read_b64_tr_b16 v[62:63], v6 offset:10752
    s_add_u32 s78, s78, 4096
    buffer_load_dwordx4 v[176:179], v1, s[28:31], s78 offen offset:0 sc1
    v_mfma_f32_32x32x16_bf16 v[80:95], v[44:47], v[140:143], v[80:95]
    ds_read_b64_tr_b16 v[40:41], v5 offset:12288
    ds_read_b64_tr_b16 v[42:43], v5 offset:12800
    buffer_load_dwordx4 v[180:183], v1, s[28:31], s78 offen offset:1024 sc1
    s_waitcnt vmcnt(9) lgkmcnt(6)
    v_mfma_f32_32x32x16_bf16 v[64:79], v[48:51], v[144:147], v[64:79]
    ds_read_b64_tr_b16 v[44:45], v6 offset:12288
    ds_read_b64_tr_b16 v[46:47], v6 offset:12800
    buffer_load_dwordx4 v[184:187], v1, s[28:31], s78 offen offset:2048 sc1
    v_mfma_f32_32x32x16_bf16 v[80:95], v[52:55], v[144:147], v[80:95]
    ds_read_b64_tr_b16 v[48:49], v5 offset:14336
    ds_read_b64_tr_b16 v[50:51], v5 offset:14848
    buffer_load_dwordx4 v[188:191], v1, s[28:31], s78 offen offset:3072 sc1
    s_waitcnt vmcnt(10) lgkmcnt(6)
    v_mfma_f32_32x32x16_bf16 v[64:79], v[56:59], v[148:151], v[64:79]
    ds_read_b64_tr_b16 v[52:53], v6 offset:14336
    ds_read_b64_tr_b16 v[54:55], v6 offset:14848
    s_add_u32 s78, s78, 4096
    buffer_load_dwordx4 v[192:195], v1, s[28:31], s78 offen offset:0 sc1
    v_mfma_f32_32x32x16_bf16 v[80:95], v[60:63], v[148:151], v[80:95]
    s_add_u32 s57, s56, 425984
    s_add_u32 s57, s57, s83
    s_and_b32 s57, s57, 0x1ffff
    v_add_u32 v5, s57, v12
    ds_read_b64_tr_b16 v[56:57], v5 offset:0
    ds_read_b64_tr_b16 v[58:59], v5 offset:512
    buffer_load_dwordx4 v[196:199], v1, s[28:31], s78 offen offset:1024 sc1
    s_waitcnt vmcnt(11) lgkmcnt(6)
    v_mfma_f32_32x32x16_bf16 v[64:79], v[40:43], v[152:155], v[64:79]
    s_add_u32 s57, s56, 425984
    s_add_u32 s57, s57, s83
    s_and_b32 s57, s57, 0x1ffff
    v_add_u32 v6, s57, v13
    ds_read_b64_tr_b16 v[60:61], v6 offset:0
    ds_read_b64_tr_b16 v[62:63], v6 offset:512
    buffer_load_dwordx4 v[200:203], v1, s[28:31], s78 offen offset:2048 sc1
    v_mfma_f32_32x32x16_bf16 v[80:95], v[44:47], v[152:155], v[80:95]
    ds_read_b64_tr_b16 v[40:41], v5 offset:2048
    ds_read_b64_tr_b16 v[42:43], v5 offset:2560
    buffer_load_dwordx4 v[204:207], v1, s[28:31], s78 offen offset:3072 sc1
    s_waitcnt vmcnt(12) lgkmcnt(6)
    v_mfma_f32_32x32x16_bf16 v[64:79], v[48:51], v[156:159], v[64:79]
    ds_read_b64_tr_b16 v[44:45], v6 offset:2048
    ds_read_b64_tr_b16 v[46:47], v6 offset:2560
    s_add_u32 s78, s78, 4096
    buffer_load_dwordx4 v[208:211], v1, s[28:31], s78 offen offset:0 sc1
    v_mfma_f32_32x32x16_bf16 v[80:95], v[52:55], v[156:159], v[80:95]
    ds_read_b64_tr_b16 v[48:49], v5 offset:4096
    ds_read_b64_tr_b16 v[50:51], v5 offset:4608
    buffer_load_dwordx4 v[212:215], v1, s[28:31], s78 offen offset:1024 sc1
    s_barrier
    s_waitcnt vmcnt(13) lgkmcnt(6)
    v_mfma_f32_32x32x16_bf16 v[64:79], v[56:59], v[160:163], v[64:79]
    ds_read_b64_tr_b16 v[52:53], v6 offset:4096
    ds_read_b64_tr_b16 v[54:55], v6 offset:4608
    buffer_load_dwordx4 v[216:219], v1, s[28:31], s78 offen offset:2048 sc1
    v_mfma_f32_32x32x16_bf16 v[80:95], v[60:63], v[160:163], v[80:95]
    ds_read_b64_tr_b16 v[56:57], v5 offset:6144
    ds_read_b64_tr_b16 v[58:59], v5 offset:6656
    buffer_load_dwordx4 v[220:223], v1, s[28:31], s78 offen offset:3072 sc1
    s_waitcnt vmcnt(14) lgkmcnt(6)
    v_mfma_f32_32x32x16_bf16 v[64:79], v[40:43], v[164:167], v[64:79]
    ds_read_b64_tr_b16 v[60:61], v6 offset:6144
    ds_read_b64_tr_b16 v[62:63], v6 offset:6656
    s_add_u32 s78, s78, 4096
    buffer_load_dwordx4 v[224:227], v1, s[28:31], s78 offen offset:0 sc1
    v_mfma_f32_32x32x16_bf16 v[80:95], v[44:47], v[164:167], v[80:95]
    ds_read_b64_tr_b16 v[40:41], v5 offset:8192
    ds_read_b64_tr_b16 v[42:43], v5 offset:8704
    buffer_load_dwordx4 v[228:231], v1, s[28:31], s78 offen offset:1024 sc1
    s_waitcnt vmcnt(15) lgkmcnt(6)
    v_mfma_f32_32x32x16_bf16 v[64:79], v[48:51], v[168:171], v[64:79]
    ds_read_b64_tr_b16 v[44:45], v6 offset:8192
    ds_read_b64_tr_b16 v[46:47], v6 offset:8704
    buffer_load_dwordx4 v[232:235], v1, s[28:31], s78 offen offset:2048 sc1
    v_mfma_f32_32x32x16_bf16 v[80:95], v[52:55], v[168:171], v[80:95]
    ds_read_b64_tr_b16 v[48:49], v5 offset:10240
    ds_read_b64_tr_b16 v[50:51], v5 offset:10752
    buffer_load_dwordx4 v[236:239], v1, s[28:31], s78 offen offset:3072 sc1
    s_waitcnt vmcnt(16) lgkmcnt(6)
    v_mfma_f32_32x32x16_bf16 v[64:79], v[56:59], v[172:175], v[64:79]
    ds_read_b64_tr_b16 v[52:53], v6 offset:10240
    ds_read_b64_tr_b16 v[54:55], v6 offset:10752
    s_add_u32 s78, s78, 4096
    buffer_load_dwordx4 v[240:243], v1, s[28:31], s78 offen offset:0 sc1
    v_mfma_f32_32x32x16_bf16 v[80:95], v[60:63], v[172:175], v[80:95]
    ds_read_b64_tr_b16 v[56:57], v5 offset:12288
    ds_read_b64_tr_b16 v[58:59], v5 offset:12800
    buffer_load_dwordx4 v[244:247], v1, s[28:31], s78 offen offset:1024 sc1
    s_waitcnt vmcnt(17) lgkmcnt(6)
    v_mfma_f32_32x32x16_bf16 v[64:79], v[40:43], v[176:179], v[64:79]
    ds_read_b64_tr_b16 v[60:61], v6 offset:12288
    ds_read_b64_tr_b16 v[62:63], v6 offset:12800
    buffer_load_dwordx4 v[248:251], v1, s[28:31], s78 offen offset:2048 sc1
    v_mfma_f32_32x32x16_bf16 v[80:95], v[44:47], v[176:179], v[80:95]
    ds_read_b64_tr_b16 v[40:41], v5 offset:14336
    ds_read_b64_tr_b16 v[42:43], v5 offset:14848
    buffer_load_dwordx4 v[252:255], v1, s[28:31], s78 offen offset:3072 sc1
    s_waitcnt vmcnt(18) lgkmcnt(6)
    v_mfma_f32_32x32x16_bf16 v[64:79], v[48:51], v[180:183], v[64:79]
    ds_read_b64_tr_b16 v[44:45], v6 offset:14336
    ds_read_b64_tr_b16 v[46:47], v6 offset:14848
    s_add_u32 s78, s78, 4096
    buffer_load_dwordx4 v[128:131], v1, s[28:31], s78 offen offset:0 sc1
    v_mfma_f32_32x32x16_bf16 v[80:95], v[52:55], v[180:183], v[80:95]
    s_add_u32 s57, s56, 458752
    s_add_u32 s57, s57, s83
    s_and_b32 s57, s57, 0x1ffff
    v_add_u32 v5, s57, v12
    ds_read_b64_tr_b16 v[48:49], v5 offset:0
    ds_read_b64_tr_b16 v[50:51], v5 offset:512
    buffer_load_dwordx4 v[132:135], v1, s[28:31], s78 offen offset:1024 sc1
    s_waitcnt vmcnt(19) lgkmcnt(6)
    v_mfma_f32_32x32x16_bf16 v[64:79], v[56:59], v[184:187], v[64:79]
    s_add_u32 s57, s56, 458752
    s_add_u32 s57, s57, s83
    s_and_b32 s57, s57, 0x1ffff
    v_add_u32 v6, s57, v13
    ds_read_b64_tr_b16 v[52:53], v6 offset:0
    ds_read_b64_tr_b16 v[54:55], v6 offset:512
    buffer_load_dwordx4 v[136:139], v1, s[28:31], s78 offen offset:2048 sc1
    v_mfma_f32_32x32x16_bf16 v[80:95], v[60:63], v[184:187], v[80:95]
    ds_read_b64_tr_b16 v[56:57], v5 offset:2048
    ds_read_b64_tr_b16 v[58:59], v5 offset:2560
    buffer_load_dwordx4 v[140:143], v1, s[28:31], s78 offen offset:3072 sc1
    s_waitcnt vmcnt(20) lgkmcnt(6)
    v_mfma_f32_32x32x16_bf16 v[64:79], v[40:43], v[188:191], v[64:79]
    ds_read_b64_tr_b16 v[60:61], v6 offset:2048
    ds_read_b64_tr_b16 v[62:63], v6 offset:2560
    s_add_u32 s78, s78, 4096
    buffer_load_dwordx4 v[144:147], v1, s[28:31], s78 offen offset:0 sc1
    v_mfma_f32_32x32x16_bf16 v[80:95], v[44:47], v[188:191], v[80:95]
    ds_read_b64_tr_b16 v[40:41], v5 offset:4096
    ds_read_b64_tr_b16 v[42:43], v5 offset:4608
    buffer_load_dwordx4 v[148:151], v1, s[28:31], s78 offen offset:1024 sc1
    s_barrier
    s_waitcnt vmcnt(21) lgkmcnt(6)
    v_mfma_f32_32x32x16_bf16 v[64:79], v[48:51], v[192:195], v[64:79]
    ds_read_b64_tr_b16 v[44:45], v6 offset:4096
    ds_read_b64_tr_b16 v[46:47], v6 offset:4608
    buffer_load_dwordx4 v[152:155], v1, s[28:31], s78 offen offset:2048 sc1
    v_mfma_f32_32x32x16_bf16 v[80:95], v[52:55], v[192:195], v[80:95]
    ds_read_b64_tr_b16 v[48:49], v5 offset:6144
    ds_read_b64_tr_b16 v[50:51], v5 offset:6656
    buffer_load_dwordx4 v[156:159], v1, s[28:31], s78 offen offset:3072 sc1
    s_waitcnt vmcnt(22) lgkmcnt(6)
    v_mfma_f32_32x32x16_bf16 v[64:79], v[56:59], v[196:199], v[64:79]
    ds_read_b64_tr_b16 v[52:53], v6 offset:6144
    ds_read_b64_tr_b16 v[54:55], v6 offset:6656
    s_add_u32 s78, s78, 4096
    buffer_load_dwordx4 v[160:163], v1, s[28:31], s78 offen offset:0 sc1
    v_mfma_f32_32x32x16_bf16 v[80:95], v[60:63], v[196:199], v[80:95]
    ds_read_b64_tr_b16 v[56:57], v5 offset:8192
    ds_read_b64_tr_b16 v[58:59], v5 offset:8704
    buffer_load_dwordx4 v[164:167], v1, s[28:31], s78 offen offset:1024 sc1
    s_waitcnt vmcnt(23) lgkmcnt(6)
    v_mfma_f32_32x32x16_bf16 v[64:79], v[40:43], v[200:203], v[64:79]
    ds_read_b64_tr_b16 v[60:61], v6 offset:8192
    ds_read_b64_tr_b16 v[62:63], v6 offset:8704
    buffer_load_dwordx4 v[168:171], v1, s[28:31], s78 offen offset:2048 sc1
    v_mfma_f32_32x32x16_bf16 v[80:95], v[44:47], v[200:203], v[80:95]
    ds_read_b64_tr_b16 v[40:41], v5 offset:10240
    ds_read_b64_tr_b16 v[42:43], v5 offset:10752
    s_waitcnt vmcnt(23) lgkmcnt(6)
    v_mfma_f32_32x32x16_bf16 v[64:79], v[48:51], v[204:207], v[64:79]
    ds_read_b64_tr_b16 v[44:45], v6 offset:10240
    ds_read_b64_tr_b16 v[46:47], v6 offset:10752
    v_mfma_f32_32x32x16_bf16 v[80:95], v[52:55], v[204:207], v[80:95]
    ds_read_b64_tr_b16 v[48:49], v5 offset:12288
    ds_read_b64_tr_b16 v[50:51], v5 offset:12800
    s_waitcnt vmcnt(22) lgkmcnt(6)
    v_mfma_f32_32x32x16_bf16 v[64:79], v[56:59], v[208:211], v[64:79]
    ds_read_b64_tr_b16 v[52:53], v6 offset:12288
    ds_read_b64_tr_b16 v[54:55], v6 offset:12800
    v_mfma_f32_32x32x16_bf16 v[80:95], v[60:63], v[208:211], v[80:95]
    ds_read_b64_tr_b16 v[56:57], v5 offset:14336
    ds_read_b64_tr_b16 v[58:59], v5 offset:14848
    s_waitcnt vmcnt(21) lgkmcnt(6)
    v_mfma_f32_32x32x16_bf16 v[64:79], v[40:43], v[212:215], v[64:79]
    ds_read_b64_tr_b16 v[60:61], v6 offset:14336
    ds_read_b64_tr_b16 v[62:63], v6 offset:14848
    v_mfma_f32_32x32x16_bf16 v[80:95], v[44:47], v[212:215], v[80:95]
    s_add_u32 s57, s56, 491520
    s_add_u32 s57, s57, s83
    s_and_b32 s57, s57, 0x1ffff
    v_add_u32 v5, s57, v12
    ds_read_b64_tr_b16 v[40:41], v5 offset:0
    ds_read_b64_tr_b16 v[42:43], v5 offset:512
    s_waitcnt vmcnt(20) lgkmcnt(6)
    v_mfma_f32_32x32x16_bf16 v[64:79], v[48:51], v[216:219], v[64:79]
    s_add_u32 s57, s56, 491520
    s_add_u32 s57, s57, s83
    s_and_b32 s57, s57, 0x1ffff
    v_add_u32 v6, s57, v13
    ds_read_b64_tr_b16 v[44:45], v6 offset:0
    ds_read_b64_tr_b16 v[46:47], v6 offset:512
    v_mfma_f32_32x32x16_bf16 v[80:95], v[52:55], v[216:219], v[80:95]
    ds_read_b64_tr_b16 v[48:49], v5 offset:2048
    ds_read_b64_tr_b16 v[50:51], v5 offset:2560
    s_waitcnt vmcnt(19) lgkmcnt(6)
    v_mfma_f32_32x32x16_bf16 v[64:79], v[56:59], v[220:223], v[64:79]
    ds_read_b64_tr_b16 v[52:53], v6 offset:2048
    ds_read_b64_tr_b16 v[54:55], v6 offset:2560
    v_mfma_f32_32x32x16_bf16 v[80:95], v[60:63], v[220:223], v[80:95]
    ds_read_b64_tr_b16 v[56:57], v5 offset:4096
    ds_read_b64_tr_b16 v[58:59], v5 offset:4608
    s_barrier
    s_waitcnt vmcnt(18) lgkmcnt(6)
    v_mfma_f32_32x32x16_bf16 v[64:79], v[40:43], v[224:227], v[64:79]
    ds_read_b64_tr_b16 v[60:61], v6 offset:4096
    ds_read_b64_tr_b16 v[62:63], v6 offset:4608
    v_mfma_f32_32x32x16_bf16 v[80:95], v[44:47], v[224:227], v[80:95]
    ds_read_b64_tr_b16 v[40:41], v5 offset:6144
    ds_read_b64_tr_b16 v[42:43], v5 offset:6656
    s_waitcnt vmcnt(17) lgkmcnt(6)
    v_mfma_f32_32x32x16_bf16 v[64:79], v[48:51], v[228:231], v[64:79]
    ds_read_b64_tr_b16 v[44:45], v6 offset:6144
    ds_read_b64_tr_b16 v[46:47], v6 offset:6656
    v_mfma_f32_32x32x16_bf16 v[80:95], v[52:55], v[228:231], v[80:95]
    ds_read_b64_tr_b16 v[48:49], v5 offset:8192
    ds_read_b64_tr_b16 v[50:51], v5 offset:8704
    s_waitcnt vmcnt(16) lgkmcnt(6)
    v_mfma_f32_32x32x16_bf16 v[64:79], v[56:59], v[232:235], v[64:79]
    ds_read_b64_tr_b16 v[52:53], v6 offset:8192
    ds_read_b64_tr_b16 v[54:55], v6 offset:8704
    v_mfma_f32_32x32x16_bf16 v[80:95], v[60:63], v[232:235], v[80:95]
    ds_read_b64_tr_b16 v[56:57], v5 offset:10240
    ds_read_b64_tr_b16 v[58:59], v5 offset:10752
    s_waitcnt vmcnt(15) lgkmcnt(6)
    v_mfma_f32_32x32x16_bf16 v[64:79], v[40:43], v[236:239], v[64:79]
    ds_read_b64_tr_b16 v[60:61], v6 offset:10240
    ds_read_b64_tr_b16 v[62:63], v6 offset:10752
    v_mfma_f32_32x32x16_bf16 v[80:95], v[44:47], v[236:239], v[80:95]
    ds_read_b64_tr_b16 v[40:41], v5 offset:12288
    ds_read_b64_tr_b16 v[42:43], v5 offset:12800
    s_waitcnt vmcnt(14) lgkmcnt(6)
    v_mfma_f32_32x32x16_bf16 v[64:79], v[48:51], v[240:243], v[64:79]
    ds_read_b64_tr_b16 v[44:45], v6 offset:12288
    ds_read_b64_tr_b16 v[46:47], v6 offset:12800
    v_mfma_f32_32x32x16_bf16 v[80:95], v[52:55], v[240:243], v[80:95]
    ds_read_b64_tr_b16 v[48:49], v5 offset:14336
    ds_read_b64_tr_b16 v[50:51], v5 offset:14848
    s_waitcnt vmcnt(13) lgkmcnt(6)
    v_mfma_f32_32x32x16_bf16 v[64:79], v[56:59], v[244:247], v[64:79]
    ds_read_b64_tr_b16 v[52:53], v6 offset:14336
    ds_read_b64_tr_b16 v[54:55], v6 offset:14848
    v_mfma_f32_32x32x16_bf16 v[80:95], v[60:63], v[244:247], v[80:95]
    s_add_u32 s57, s56, 524288
    s_add_u32 s57, s57, s83
    s_and_b32 s57, s57, 0x1ffff
    v_add_u32 v5, s57, v12
    ds_read_b64_tr_b16 v[56:57], v5 offset:0
    ds_read_b64_tr_b16 v[58:59], v5 offset:512
    s_waitcnt vmcnt(12) lgkmcnt(6)
    v_mfma_f32_32x32x16_bf16 v[64:79], v[40:43], v[248:251], v[64:79]
    s_add_u32 s57, s56, 524288
    s_add_u32 s57, s57, s83
    s_and_b32 s57, s57, 0x1ffff
    v_add_u32 v6, s57, v13
    ds_read_b64_tr_b16 v[60:61], v6 offset:0
    ds_read_b64_tr_b16 v[62:63], v6 offset:512
    v_mfma_f32_32x32x16_bf16 v[80:95], v[44:47], v[248:251], v[80:95]
    ds_read_b64_tr_b16 v[40:41], v5 offset:2048
    ds_read_b64_tr_b16 v[42:43], v5 offset:2560
    s_waitcnt vmcnt(11) lgkmcnt(6)
    v_mfma_f32_32x32x16_bf16 v[64:79], v[48:51], v[252:255], v[64:79]
    ds_read_b64_tr_b16 v[44:45], v6 offset:2048
    ds_read_b64_tr_b16 v[46:47], v6 offset:2560
    v_mfma_f32_32x32x16_bf16 v[80:95], v[52:55], v[252:255], v[80:95]
    ds_read_b64_tr_b16 v[48:49], v5 offset:4096
    ds_read_b64_tr_b16 v[50:51], v5 offset:4608
    s_barrier
    s_waitcnt vmcnt(10) lgkmcnt(6)
    v_mfma_f32_32x32x16_bf16 v[64:79], v[56:59], v[128:131], v[64:79]
    ds_read_b64_tr_b16 v[52:53], v6 offset:4096
    ds_read_b64_tr_b16 v[54:55], v6 offset:4608
    v_mfma_f32_32x32x16_bf16 v[80:95], v[60:63], v[128:131], v[80:95]
    ds_read_b64_tr_b16 v[56:57], v5 offset:6144
    ds_read_b64_tr_b16 v[58:59], v5 offset:6656
    s_waitcnt vmcnt(9) lgkmcnt(6)
    v_mfma_f32_32x32x16_bf16 v[64:79], v[40:43], v[132:135], v[64:79]
    ds_read_b64_tr_b16 v[60:61], v6 offset:6144
    ds_read_b64_tr_b16 v[62:63], v6 offset:6656
    v_mfma_f32_32x32x16_bf16 v[80:95], v[44:47], v[132:135], v[80:95]
    ds_read_b64_tr_b16 v[40:41], v5 offset:8192
    ds_read_b64_tr_b16 v[42:43], v5 offset:8704
    s_waitcnt vmcnt(8) lgkmcnt(6)
    v_mfma_f32_32x32x16_bf16 v[64:79], v[48:51], v[136:139], v[64:79]
    ds_read_b64_tr_b16 v[44:45], v6 offset:8192
    ds_read_b64_tr_b16 v[46:47], v6 offset:8704
    v_mfma_f32_32x32x16_bf16 v[80:95], v[52:55], v[136:139], v[80:95]
    ds_read_b64_tr_b16 v[48:49], v5 offset:10240
    ds_read_b64_tr_b16 v[50:51], v5 offset:10752
    s_waitcnt vmcnt(7) lgkmcnt(6)
    v_mfma_f32_32x32x16_bf16 v[64:79], v[56:59], v[140:143], v[64:79]
    ds_read_b64_tr_b16 v[52:53], v6 offset:10240
    ds_read_b64_tr_b16 v[54:55], v6 offset:10752
    v_mfma_f32_32x32x16_bf16 v[80:95], v[60:63], v[140:143], v[80:95]
    ds_read_b64_tr_b16 v[56:57], v5 offset:12288
    ds_read_b64_tr_b16 v[58:59], v5 offset:12800
    s_waitcnt vmcnt(6) lgkmcnt(6)
    v_mfma_f32_32x32x16_bf16 v[64:79], v[40:43], v[144:147], v[64:79]
    ds_read_b64_tr_b16 v[60:61], v6 offset:12288
    ds_read_b64_tr_b16 v[62:63], v6 offset:12800
    v_mfma_f32_32x32x16_bf16 v[80:95], v[44:47], v[144:147], v[80:95]
    ds_read_b64_tr_b16 v[40:41], v5 offset:14336
    ds_read_b64_tr_b16 v[42:43], v5 offset:14848
    s_waitcnt vmcnt(5) lgkmcnt(6)
    v_mfma_f32_32x32x16_bf16 v[64:79], v[48:51], v[148:151], v[64:79]
    ds_read_b64_tr_b16 v[44:45], v6 offset:14336
    ds_read_b64_tr_b16 v[46:47], v6 offset:14848
    v_mfma_f32_32x32x16_bf16 v[80:95], v[52:55], v[148:151], v[80:95]
    s_add_u32 s57, s56, 557056
    s_and_b32 s57, s57, 0x1ffff
    s_add_u32 s57, s57, s87
    v_add_u32 v5, s57, v12
    ds_read_b64_tr_b16 v[48:49], v5 offset:0
    ds_read_b64_tr_b16 v[50:51], v5 offset:512
    s_waitcnt vmcnt(4) lgkmcnt(6)
    v_mfma_f32_32x32x16_bf16 v[64:79], v[56:59], v[152:155], v[64:79]
    s_add_u32 s57, s56, 557056
    s_and_b32 s57, s57, 0x1ffff
    s_add_u32 s57, s57, s87
    v_add_u32 v6, s57, v13
    ds_read_b64_tr_b16 v[52:53], v6 offset:0
    ds_read_b64_tr_b16 v[54:55], v6 offset:512
    v_mfma_f32_32x32x16_bf16 v[80:95], v[60:63], v[152:155], v[80:95]
    ds_read_b64_tr_b16 v[56:57], v5 offset:2048
    ds_read_b64_tr_b16 v[58:59], v5 offset:2560
    s_waitcnt vmcnt(3) lgkmcnt(6)
    v_mfma_f32_32x32x16_bf16 v[64:79], v[40:43], v[156:159], v[64:79]
    ds_read_b64_tr_b16 v[60:61], v6 offset:2048
    ds_read_b64_tr_b16 v[62:63], v6 offset:2560
    v_mfma_f32_32x32x16_bf16 v[80:95], v[44:47], v[156:159], v[80:95]
    ds_read_b64_tr_b16 v[40:41], v5 offset:4096
    ds_read_b64_tr_b16 v[42:43], v5 offset:4608
    s_barrier
    s_waitcnt vmcnt(2) lgkmcnt(6)
    v_mfma_f32_32x32x16_bf16 v[64:79], v[48:51], v[160:163], v[64:79]
    ds_read_b64_tr_b16 v[44:45], v6 offset:4096
    ds_read_b64_tr_b16 v[46:47], v6 offset:4608
    v_mfma_f32_32x32x16_bf16 v[80:95], v[52:55], v[160:163], v[80:95]
    s_waitcnt vmcnt(1) lgkmcnt(4)
    v_mfma_f32_32x32x16_bf16 v[64:79], v[56:59], v[164:167], v[64:79]
    v_mfma_f32_32x32x16_bf16 v[80:95], v[60:63], v[164:167], v[80:95]
    s_waitcnt vmcnt(0) lgkmcnt(0)
    v_mfma_f32_32x32x16_bf16 v[64:79], v[40:43], v[168:171], v[64:79]
    v_mfma_f32_32x32x16_bf16 v[80:95], v[44:47], v[168:171], v[80:95]
    s_lshl_b32 s57, s20, 12
    s_add_u32 s57, s57, 131072
    v_add_u32 v8, s57, v1
    s_xor_b32 s58, s57, 0x2000
    v_add_u32 v9, s58, v1
    s_nop 6
    ds_write_b128 v8, v[80:83] offset:0
    ds_write_b128 v8, v[84:87] offset:1024
    ds_write_b128 v8, v[88:91] offset:2048
    ds_write_b128 v8, v[92:95] offset:3072
    s_waitcnt lgkmcnt(0)
    s_barrier
    ds_read_b128 v[96:99], v9 offset:0
    ds_read_b128 v[100:103], v9 offset:1024
    ds_read_b128 v[104:107], v9 offset:2048
    ds_read_b128 v[108:111], v9 offset:3072
    s_waitcnt lgkmcnt(3)
    v_pk_add_f32 v[64:65], v[64:65], v[96:97]
    v_pk_add_f32 v[66:67], v[66:67], v[98:99]
    s_waitcnt lgkmcnt(2)
    v_pk_add_f32 v[68:69], v[68:69], v[100:101]
    v_pk_add_f32 v[70:71], v[70:71], v[102:103]
    s_waitcnt lgkmcnt(1)
    v_pk_add_f32 v[72:73], v[72:73], v[104:105]
    v_pk_add_f32 v[74:75], v[74:75], v[106:107]
    s_waitcnt lgkmcnt(0)
    v_pk_add_f32 v[76:77], v[76:77], v[108:109]
    v_pk_add_f32 v[78:79], v[78:79], v[110:111]
    v_cvt_pk_bf16_f32 v16, v64, v65
    v_cvt_pk_bf16_f32 v17, v66, v67
    v_cvt_pk_bf16_f32 v18, v68, v69
    v_cvt_pk_bf16_f32 v19, v70, v71
    v_cvt_pk_bf16_f32 v20, v72, v73
    v_cvt_pk_bf16_f32 v21, v74, v75
    v_cvt_pk_bf16_f32 v22, v76, v77
    v_cvt_pk_bf16_f32 v23, v78, v79
    v_pk_mul_f32 v[96:97], v[64:65], v[64:65]
    v_pk_add_f32 v[98:99], v[64:65], v[66:67]
    v_pk_fma_f32 v[96:97], v[66:67], v[66:67], v[96:97]
    v_pk_add_f32 v[98:99], v[98:99], v[68:69]
    v_pk_fma_f32 v[96:97], v[68:69], v[68:69], v[96:97]
    v_pk_add_f32 v[98:99], v[98:99], v[70:71]
    v_pk_fma_f32 v[96:97], v[70:71], v[70:71], v[96:97]
    v_pk_add_f32 v[98:99], v[98:99], v[72:73]
    v_pk_fma_f32 v[96:97], v[72:73], v[72:73], v[96:97]
    v_pk_add_f32 v[98:99], v[98:99], v[74:75]
    v_pk_fma_f32 v[96:97], v[74:75], v[74:75], v[96:97]
    v_pk_add_f32 v[98:99], v[98:99], v[76:77]
    v_pk_fma_f32 v[96:97], v[76:77], v[76:77], v[96:97]
    v_pk_add_f32 v[98:99], v[98:99], v[78:79]
    v_pk_fma_f32 v[96:97], v[78:79], v[78:79], v[96:97]
    v_permlane32_swap_b32 v16, v18
    v_permlane32_swap_b32 v17, v19
    v_permlane32_swap_b32 v20, v22
    v_permlane32_swap_b32 v21, v23
    v_add_f32 v98, v98, v99
    v_add_f32 v96, v96, v97
    s_nop 1
    v_permlane32_swap_b32 v98, v96
    v_add_f32 v98, v98, v96
    v_and_b32 v10, 31, v0
    v_lshlrev_b32 v10, 4, v10
    v_lshrrev_b32 v11, 5, v0
    v_lshl_add_u32 v10, v11, 2, v10
    s_lshl_b32 s58, s53, 9
    s_lshl_b32 s59, s51, 3
    s_add_u32 s81, s58, s59
    s_cmp_eq_u32 s48, 1
    s_cbranch_scc1 Lfinal_C_21
    s_mov_b32 s76, 196608
    s_mov_b32 s77, 4096
    s_add_u32 s57, s80, s76
    buffer_store_dwordx4 v[16:19], v1, s[32:35], s57 offen offset:0
    buffer_store_dwordx4 v[16:19], v1, s[36:39], s57 offen offset:0 sc1
    buffer_store_dwordx4 v[20:23], v1, s[32:35], s57 offen offset:1024
    buffer_store_dwordx4 v[20:23], v1, s[36:39], s57 offen offset:1024 sc1
    s_lshl_b32 s58, s55, 12
    s_add_u32 s58, s58, s81
    s_add_u32 s58, s58, s77
    buffer_store_dword v98, v10, s[32:35], s58 offen offset:0
    buffer_store_dword v98, v10, s[36:39], s58 offen offset:0 sc1
    s_and_b32 s57, s52, s50
    s_cmp_eq_u32 s57, 0
    s_cbranch_scc1 Lnohalo_C_23
    s_cmp_eq_u32 s21, 15
    s_cbranch_scc1 Lnohalo_C_23
    s_lshl_b32 s59, s53, 12
    s_lshl_b32 s57, s51, 11
    s_add_u32 s59, s59, s57
    s_add_u32 s59, s59, 2228224
    buffer_store_dwordx4 v[16:19], v1, s[28:31], s59 offen sc1
    buffer_store_dwordx4 v[20:23], v1, s[28:31], s59 offen offset:1024 sc1
    s_add_u32 s59, s81, 2170880
    buffer_store_dword v98, v10, s[28:31], s59 offen sc1
    s_waitcnt vmcnt(3)
    s_add_u32 s57, s23, s49
    s_add_u32 s57, s57, 1
    v_mov_b32 v7, s57
    s_mov_b64 exec, 1
    buffer_store_dword v7, v4, s[32:35], 0 offen
    buffer_store_dword v7, v4, s[36:39], 0 offen sc1
    s_waitcnt vmcnt(2)
    s_lshl_b32 s57, s53, 3
    s_lshl_b32 s58, s51, 2
    s_add_u32 s57, s57, s58
    s_add_u32 s57, s57, 2097728
    v_mov_b32 v7, s57
    s_add_u32 s57, s24, 1
    v_mov_b32 v8, s57
    buffer_store_dword v8, v7, s[28:31], 0 offen sc1
    s_mov_b64 exec, -1
    s_add_u32 s49, s49, 1
    s_branch Lhalod_C_24
Lnohalo_C_23:
    s_add_u32 s49, s49, 1
    s_waitcnt vmcnt(0)
    s_add_u32 s57, s23, s49
    v_mov_b32 v7, s57
    s_mov_b64 exec, 1
    buffer_store_dword v7, v4, s[32:35], 0 offen
    buffer_store_dword v7, v4, s[36:39], 0 offen sc1
    s_mov_b64 exec, -1
Lhalod_C_24:
    s_mov_b32 s48, 1
    s_branch L_layer
Lfinal_C_21:
    s_nop 1
    v_and_b32 v7, 31, v0
    s_lshl_b32 s57, s98, 5
    v_add_u32 v7, s57, v7
    v_lshlrev_b32 v7, 10, v7
    v_lshrrev_b32 v8, 5, v0
    v_lshl_add_u32 v7, v8, 4, v7
    s_lshl_b32 s57, s53, 7
    s_lshl_b32 s58, s51, 6
    s_add_u32 s57, s57, s58
    buffer_store_dwordx4 v[16:19], v7, s[44:47], s57 offen
    buffer_store_dwordx4 v[20:23], v7, s[44:47], s57 offen offset:32
    s_waitcnt vmcnt(0)
    s_or_b32 s57, s22, s20
    s_cmp_lg_u32 s57, 0
    s_cbranch_scc1 L_fin
    v_mov_b32 v7, 768
    s_add_u32 s58, s23, 256
    v_mov_b32 v8, s58
    s_mov_b64 exec, 1
    buffer_store_dword v8, v7, s[28:31], 0 offen
    s_branch L_fin
L_helper:
    s_nop 4
    s_mov_b32 s32, s6
    s_mov_b32 s33, s7
    s_mov_b32 s34, 1572864
    s_mov_b32 s35, 0x00020000
    s_mov_b32 s36, s8
    s_mov_b32 s37, s9
    s_mov_b32 s38, 524288
    s_mov_b32 s39, 0x00020000
    s_mov_b32 s40, s12
    s_mov_b32 s41, s13
    s_mov_b32 s42, 1409024
    s_mov_b32 s43, 0x00020000
    s_mov_b32 s44, s14
    s_mov_b32 s45, s15
    s_mov_b32 s46, 1409024
    s_mov_b32 s47, 0x00020000
    s_mov_b32 s48, s10
    s_mov_b32 s49, s11
    s_mov_b32 s50, 1409024
    s_mov_b32 s51, 0x00020000
    s_sub_u32 s52, s20, 4
    s_lshr_b32 s53, s22, 3
    s_and_b32 s54, s22, 7
    v_lshrrev_b32 v2, 2, v0
    v_and_b32 v3, 3, v0
    v_lshlrev_b32 v3, 4, v3
    v_mul_u32_u24 v4, 3072, v2
    v_add_u32 v4, v4, v3
    v_lshrrev_b32 v5, 3, v0
    v_lshlrev_b32 v5, 10, v5
    v_bfe_u32 v8, v0, 4, 1
    v_lshlrev_b32 v8, 2, v8
    v_and_b32 v9, 7, v0
    v_xor_b32 v8, v8, v9
    v_lshl_add_u32 v5, v8, 4, v5
    s_lshl_b32 s55, s22, 6
    s_lshl_b32 s56, s54, 7
    s_lshl_b32 s57, s22, 3
    s_mul_hi_u32 s57, s57, 0x55555556
    s_lshl_b32 s57, s57, 6
    s_mul_i32 s58, s52, 64*3072
    s_mul_i32 s59, s52, 32*1024
    s_mul_i32 s60, s52, 64*2752
    s_lshl_b32 s61, s52, 12
    v_add_u32 v3, s61, v1
    v_lshrrev_b32 v7, 4, v0
    v_lshlrev_b32 v7, 9, v7
    v_bfe_u32 v8, v0, 2, 2
    v_lshl_add_u32 v7, v8, 6, v7
    v_and_b32 v8, 3, v0
    v_lshl_add_u32 v7, v8, 3, v7
    s_and_b32 s64, s52, 1
    s_lshl_b32 s65, s64, 5
    v_add_u32 v7, s65, v7
    v_mov_b32 v12, 0x3f803f80
    v_mov_b32 v13, 0x3f803f80
    v_mov_b32 v14, 0x3f803f80
    v_mov_b32 v15, 0x3f803f80
    v_mov_b32 v8, 0
    v_mov_b32 v9, 0
    v_mov_b32 v10, 163344
    ds_write_b64 v10, v[8:9]
    v_lshrrev_b32 v11, 4, v0
    v_lshlrev_b32 v11, 9, v11
    v_and_b32 v8, 15, v0
    v_lshl_add_u32 v11, v8, 4, v11
    v_add_u32 v11, 256, v11
    v_and_b32 v16, 15, v0
    v_lshlrev_b32 v16, 4, v16
    v_add_u32 v16, 256, v16
    s_lshr_b32 s66, s52, 1
    s_lshl_b32 s67, s66, 9
    s_lshl_b32 s68, s64, 7
    s_add_u32 s67, s67, s68
    s_add_u32 s67, s67, 158720
    v_and_b32 v17, 15, v0
    v_lshlrev_b32 v17, 3, v17
    v_bfe_u32 v8, v0, 4, 1
    v_lshl_add_u32 v17, v8, 8, v17
    v_add_u32 v17, s67, v17
    v_mov_b32 v8, 163344
    v_cmp_gt_u32 vcc, 32, v0
    s_nop 1
    v_cndmask_b32 v17, v8, v17, vcc
    v_mov_b32 v22, 0
    v_mov_b32 v23, 0
    v_mov_b32 v26, 0
    v_mov_b32 v27, 0
    v_and_b32 v18, 15, v0
    v_lshlrev_b32 v18, 4, v18
    v_bfe_u32 v8, v0, 4, 1
    v_lshrrev_b32 v9, 5, v0
    v_mul_u32_u24 v19, 2304, v8
    v_add_u32 v19, v19, v18
    v_lshl_add_u32 v19, v9, 3, v19
    s_mul_i32 s68, s64, 4608
    s_add_u32 s68, s68, 131072
    v_add_u32 v19, s68, v19
    v_mul_u32_u24 v28, 4608, v8
    v_add_u32 v28, v28, v18
    v_mul_u32_u24 v9, 2304, v9
    v_add_u32 v28, v28, v9
    s_mul_i32 s68, s64, 9216
    s_add_u32 s68, s68, 140288
    v_add_u32 v28, s68, v28
    s_waitcnt lgkmcnt(0)
    s_add_u32 s62, s52, 0
    s_sub_u32 s63, s62, 3
    s_cmp_ge_u32 s62, 3
    s_cselect_b32 s62, s63, s62
    s_lshl_b32 s62, s62, 6
    v_add_u32 v8, s62, v0
    v_mul_u32_u24 v9, 0x5556, v8
    v_lshrrev_b32 v9, 18, v9
    v_mul_u32_u24 v30, 12, v9
    v_sub_u32 v8, v8, v30
    v_mul_u32_u24 v6, 2752, v9
    v_lshl_add_u32 v6, v8, 4, v6
    s_add_u32 s62, s52, 1
    s_sub_u32 s63, s62, 3
    s_cmp_ge_u32 s62, 3
    s_cselect_b32 s62, s63, s62
    s_lshl_b32 s62, s62, 6
    v_add_u32 v8, s62, v0
    v_mul_u32_u24 v9, 0x5556, v8
    v_lshrrev_b32 v9, 18, v9
    v_mul_u32_u24 v30, 12, v9
    v_sub_u32 v8, v8, v30
    v_mul_u32_u24 v10, 2752, v9
    v_lshl_add_u32 v10, v8, 4, v10
    s_add_u32 s62, s52, 2
    s_sub_u32 s63, s62, 3
    s_cmp_ge_u32 s62, 3
    s_cselect_b32 s62, s63, s62
    s_lshl_b32 s62, s62, 6
    v_add_u32 v8, s62, v0
    v_mul_u32_u24 v9, 0x5556, v8
    v_lshrrev_b32 v9, 18, v9
    v_mul_u32_u24 v30, 12, v9
    v_sub_u32 v8, v8, v30
    v_mul_u32_u24 v18, 2752, v9
    v_lshl_add_u32 v18, v8, 4, v18
    s_lshl_b32 s62, s2, 2
    s_add_u32 s62, s62, s52
    s_mul_i32 s62, s62, 2048
    buffer_load_dword v8, v1, s[32:35], s62 offen offset:0
    buffer_load_dword v8, v1, s[32:35], s62 offen offset:1024
    v_mov_b32 v2, 0
    s_mov_b64 exec, 1
    buffer_load_dword v36, v2, s[40:43], 0 offen
    buffer_load_dword v36, v2, s[44:47], 0 offen
    buffer_load_dword v36, v2, s[48:51], 0 offen
    s_mov_b64 exec, -1
    s_barrier
    s_add_u32 s62, s55, s58
    s_add_u32 s62, s62, 1024
    buffer_load_dwordx4 v[64:67], v4, s[32:35], s62 offen
    s_add_u32 s62, s62, 49152
    buffer_load_dwordx4 v[68:71], v4, s[32:35], s62 offen
    s_add_u32 s62, s62, 49152
    buffer_load_dwordx4 v[72:75], v4, s[32:35], s62 offen
    s_add_u32 s62, s62, 49152
    buffer_load_dwordx4 v[76:79], v4, s[32:35], s62 offen
    s_add_u32 s62, s55, s58
    s_add_u32 s62, s62, 2048
    buffer_load_dwordx4 v[80:83], v4, s[32:35], s62 offen
    s_add_u32 s62, s62, 49152
    buffer_load_dwordx4 v[84:87], v4, s[32:35], s62 offen
    s_add_u32 s62, s62, 49152
    buffer_load_dwordx4 v[88:91], v4, s[32:35], s62 offen
    s_add_u32 s62, s62, 49152
    buffer_load_dwordx4 v[92:95], v4, s[32:35], s62 offen
    s_add_u32 s62, s55, s58
    s_add_u32 s62, s62, 787456
    buffer_load_dwordx4 v[96:99], v4, s[32:35], s62 offen
    s_add_u32 s62, s62, 49152
    buffer_load_dwordx4 v[100:103], v4, s[32:35], s62 offen
    s_add_u32 s62, s62, 49152
    buffer_load_dwordx4 v[104:107], v4, s[32:35], s62 offen
    s_add_u32 s62, s62, 49152
    buffer_load_dwordx4 v[108:111], v4, s[32:35], s62 offen
    s_add_u32 s62, s55, s58
    s_add_u32 s62, s62, 788480
    buffer_load_dwordx4 v[112:115], v4, s[32:35], s62 offen
    s_add_u32 s62, s62, 49152
    buffer_load_dwordx4 v[116:119], v4, s[32:35], s62 offen
    s_add_u32 s62, s62, 49152
    buffer_load_dwordx4 v[120:123], v4, s[32:35], s62 offen
    s_add_u32 s62, s62, 49152
    buffer_load_dwordx4 v[124:127], v4, s[32:35], s62 offen
    s_add_u32 s62, s55, s58
    s_add_u32 s62, s62, 0
    buffer_load_dwordx4 v[128:131], v4, s[32:35], s62 offen
    s_add_u32 s62, s62, 49152
    buffer_load_dwordx4 v[132:135], v4, s[32:35], s62 offen
    s_add_u32 s62, s62, 49152
    buffer_load_dwordx4 v[136:139], v4, s[32:35], s62 offen
    s_add_u32 s62, s62, 49152
    buffer_load_dwordx4 v[140:143], v4, s[32:35], s62 offen
    s_add_u32 s62, s55, s58
    s_add_u32 s62, s62, 786432
    buffer_load_dwordx4 v[144:147], v4, s[32:35], s62 offen
    s_add_u32 s62, s62, 49152
    buffer_load_dwordx4 v[148:151], v4, s[32:35], s62 offen
    s_add_u32 s62, s62, 49152
    buffer_load_dwordx4 v[152:155], v4, s[32:35], s62 offen
    s_add_u32 s62, s62, 49152
    buffer_load_dwordx4 v[156:159], v4, s[32:35], s62 offen
    s_waitcnt vmcnt(20)
    v_add_u32 v2, 0, v3
    ds_write_b128 v2, v[64:67] offset:0
    ds_write_b128 v2, v[68:71] offset:1024
    ds_write_b128 v2, v[72:75] offset:2048
    ds_write_b128 v2, v[76:79] offset:3072
    s_waitcnt vmcnt(16)
    v_add_u32 v2, 16384, v3
    ds_write_b128 v2, v[80:83] offset:0
    ds_write_b128 v2, v[84:87] offset:1024
    ds_write_b128 v2, v[88:91] offset:2048
    ds_write_b128 v2, v[92:95] offset:3072
    s_mov_b32 s76, 98304
    s_mov_b32 s77, 69632
    s_waitcnt lgkmcnt(0)
    s_barrier
    s_cmp_lt_u32 s52, 2
    s_mov_b32 s69, 0
    s_cselect_b32 s69, s69, 16384
    s_mov_b32 s71, 32768
    s_cselect_b32 s71, s71, 49152
    v_add_u32 v29, s69, v7
    v_add_u32 v35, s71, v7
    s_add_u32 s75, s23, 1
    s_mov_b32 s74, 1024
    s_add_u32 s72, s18, s74
    s_addc_u32 s73, s19, 0
    ds_read_b64_tr_b16 v[160:161], v29 offset:0
    ds_read_b64_tr_b16 v[162:163], v29 offset:256
    ds_read_b64_tr_b16 v[164:165], v29 offset:2048
    ds_read_b64_tr_b16 v[166:167], v29 offset:2304
    ds_read_b64_tr_b16 v[168:169], v29 offset:4096
    ds_read_b64_tr_b16 v[170:171], v29 offset:4352
    ds_read_b64_tr_b16 v[172:173], v29 offset:6144
    ds_read_b64_tr_b16 v[174:175], v29 offset:6400
    ds_read_b64_tr_b16 v[176:177], v29 offset:8192
    ds_read_b64_tr_b16 v[178:179], v29 offset:8448
    ds_read_b64_tr_b16 v[180:181], v29 offset:10240
    ds_read_b64_tr_b16 v[182:183], v29 offset:10496
    ds_read_b64_tr_b16 v[184:185], v29 offset:12288
    ds_read_b64_tr_b16 v[186:187], v29 offset:12544
    s_waitcnt lgkmcnt(0)
    ds_read_b64_tr_b16 v[188:189], v29 offset:14336
    ds_read_b64_tr_b16 v[190:191], v29 offset:14592
    s_waitcnt lgkmcnt(0)
    v_mfma_f32_16x16x32_bf16 v[52:55], v[12:15], v[160:163], 0
    v_mfma_f32_16x16x32_bf16 v[52:55], v[12:15], v[164:167], v[52:55]
    v_mfma_f32_16x16x32_bf16 v[52:55], v[12:15], v[168:171], v[52:55]
    v_mfma_f32_16x16x32_bf16 v[52:55], v[12:15], v[172:175], v[52:55]
    v_mfma_f32_16x16x32_bf16 v[52:55], v[12:15], v[176:179], v[52:55]
    v_mfma_f32_16x16x32_bf16 v[52:55], v[12:15], v[180:183], v[52:55]
    v_mfma_f32_16x16x32_bf16 v[52:55], v[12:15], v[184:187], v[52:55]
    v_mfma_f32_16x16x32_bf16 v[52:55], v[12:15], v[188:191], v[52:55]
    s_waitcnt vmcnt(12)
    v_add_u32 v2, 32768, v3
    ds_write_b128 v2, v[96:99] offset:0
    ds_write_b128 v2, v[100:103] offset:1024
    ds_write_b128 v2, v[104:107] offset:2048
    ds_write_b128 v2, v[108:111] offset:3072
    s_waitcnt vmcnt(8)
    v_add_u32 v2, 49152, v3
    ds_write_b128 v2, v[112:115] offset:0
    ds_write_b128 v2, v[116:119] offset:1024
    ds_write_b128 v2, v[120:123] offset:2048
    ds_write_b128 v2, v[124:127] offset:3072
    s_waitcnt vmcnt(4)
    v_add_u32 v2, 65536, v3
    ds_write_b128 v2, v[128:131] offset:0
    ds_write_b128 v2, v[132:135] offset:1024
    ds_write_b128 v2, v[136:139] offset:2048
    ds_write_b128 v2, v[140:143] offset:3072
    s_waitcnt vmcnt(0)
    v_add_u32 v2, 81920, v3
    ds_write_b128 v2, v[144:147] offset:0
    ds_write_b128 v2, v[148:151] offset:1024
    s_waitcnt lgkmcnt(8)
    ds_write_b128 v2, v[152:155] offset:2048
    ds_write_b128 v2, v[156:159] offset:3072
    s_waitcnt lgkmcnt(0)
    s_barrier
    ds_read_b64_tr_b16 v[192:193], v35 offset:0
    ds_read_b64_tr_b16 v[194:195], v35 offset:256
    ds_read_b64_tr_b16 v[196:197], v35 offset:2048
    ds_read_b64_tr_b16 v[198:199], v35 offset:2304
    ds_read_b64_tr_b16 v[200:201], v35 offset:4096
    ds_read_b64_tr_b16 v[202:203], v35 offset:4352
    ds_read_b64_tr_b16 v[204:205], v35 offset:6144
    ds_read_b64_tr_b16 v[206:207], v35 offset:6400
    ds_read_b64_tr_b16 v[208:209], v35 offset:8192
    ds_read_b64_tr_b16 v[210:211], v35 offset:8448
    ds_read_b64_tr_b16 v[212:213], v35 offset:10240
    ds_read_b64_tr_b16 v[214:215], v35 offset:10496
    ds_read_b64_tr_b16 v[216:217], v35 offset:12288
    ds_read_b64_tr_b16 v[218:219], v35 offset:12544
    s_waitcnt lgkmcnt(0)
    ds_read_b64_tr_b16 v[220:221], v35 offset:14336
    ds_read_b64_tr_b16 v[222:223], v35 offset:14592
    s_waitcnt lgkmcnt(0)
    v_mfma_f32_16x16x32_bf16 v[60:63], v[12:15], v[192:195], 0
    v_mfma_f32_16x16x32_bf16 v[60:63], v[12:15], v[196:199], v[60:63]
    v_mfma_f32_16x16x32_bf16 v[60:63], v[12:15], v[200:203], v[60:63]
    v_mfma_f32_16x16x32_bf16 v[60:63], v[12:15], v[204:207], v[60:63]
    v_mfma_f32_16x16x32_bf16 v[60:63], v[12:15], v[208:211], v[60:63]
    v_mfma_f32_16x16x32_bf16 v[60:63], v[12:15], v[212:215], v[60:63]
    v_mfma_f32_16x16x32_bf16 v[60:63], v[12:15], v[216:219], v[60:63]
    v_mfma_f32_16x16x32_bf16 v[60:63], v[12:15], v[220:223], v[60:63]
    s_lshl_b32 s70, s66, 9
    s_lshl_b32 s71, s64, 7
    s_add_u32 s70, s70, s71
    s_add_u32 s70, s70, 158720
    v_cvt_pk_bf16_f32 v30, v52, v52
    v_lshlrev_b32 v30, 16, v30
    v_sub_f32 v31, v52, v30
    v_cvt_pk_bf16_f32 v32, v52, v31
    v_and_b32 v30, 0xffff0000, v32
    v_sub_f32 v31, v31, v30
    v_cvt_pk_bf16_f32 v33, v31, 0
    v_and_b32 v30, 15, v0
    v_lshlrev_b32 v30, 3, v30
    v_add_u32 v30, s70, v30
    s_mov_b64 exec, 0xffff
    ds_write_b64 v30, v[32:33]
    s_mov_b64 exec, -1
    s_add_u32 s70, s70, 256
    v_cvt_pk_bf16_f32 v30, v60, v60
    v_lshlrev_b32 v30, 16, v30
    v_sub_f32 v31, v60, v30
    v_cvt_pk_bf16_f32 v32, v60, v31
    v_and_b32 v30, 0xffff0000, v32
    v_sub_f32 v31, v31, v30
    v_cvt_pk_bf16_f32 v33, v31, 0
    v_and_b32 v30, 15, v0
    v_lshlrev_b32 v30, 3, v30
    v_add_u32 v30, s70, v30
    s_mov_b64 exec, 0xffff
    ds_write_b64 v30, v[32:33]
    s_mov_b64 exec, -1
    s_waitcnt lgkmcnt(0)
    s_cmp_lt_u32 s52, 2
    s_mov_b32 s69, 65536
    s_cselect_b32 s69, s69, 81920
    s_mov_b32 s70, 159744
    s_cselect_b32 s70, s70, 160000
    s_lshl_b32 s71, s64, 7
    s_add_u32 s70, s70, s71
    v_add_u32 v29, s69, v7
    ds_read_b64_tr_b16 v[36:37], v29 offset:0
    ds_read_b64_tr_b16 v[38:39], v29 offset:256
    ds_read_b64_tr_b16 v[40:41], v29 offset:2048
    ds_read_b64_tr_b16 v[42:43], v29 offset:2304
    ds_read_b64_tr_b16 v[44:45], v29 offset:4096
    ds_read_b64_tr_b16 v[46:47], v29 offset:4352
    ds_read_b64_tr_b16 v[48:49], v29 offset:6144
    ds_read_b64_tr_b16 v[50:51], v29 offset:6400
    s_waitcnt lgkmcnt(6)
    v_mfma_f32_16x16x32_bf16 v[52:55], v[12:15], v[36:39], 0
    ds_read_b64_tr_b16 v[36:37], v29 offset:8192
    ds_read_b64_tr_b16 v[38:39], v29 offset:8448
    s_waitcnt lgkmcnt(6)
    v_mfma_f32_16x16x32_bf16 v[52:55], v[12:15], v[40:43], v[52:55]
    ds_read_b64_tr_b16 v[40:41], v29 offset:10240
    ds_read_b64_tr_b16 v[42:43], v29 offset:10496
    s_waitcnt lgkmcnt(6)
    v_mfma_f32_16x16x32_bf16 v[52:55], v[12:15], v[44:47], v[52:55]
    ds_read_b64_tr_b16 v[44:45], v29 offset:12288
    ds_read_b64_tr_b16 v[46:47], v29 offset:12544
    s_waitcnt lgkmcnt(6)
    v_mfma_f32_16x16x32_bf16 v[52:55], v[12:15], v[48:51], v[52:55]
    ds_read_b64_tr_b16 v[48:49], v29 offset:14336
    ds_read_b64_tr_b16 v[50:51], v29 offset:14592
    s_waitcnt lgkmcnt(6)
    v_mfma_f32_16x16x32_bf16 v[52:55], v[12:15], v[36:39], v[52:55]
    s_waitcnt lgkmcnt(4)
    v_mfma_f32_16x16x32_bf16 v[52:55], v[12:15], v[40:43], v[52:55]
    s_waitcnt lgkmcnt(2)
    v_mfma_f32_16x16x32_bf16 v[52:55], v[12:15], v[44:47], v[52:55]
    s_waitcnt lgkmcnt(0)
    v_mfma_f32_16x16x32_bf16 v[52:55], v[12:15], v[48:51], v[52:55]
    s_nop 7
    v_cvt_pk_bf16_f32 v30, v52, v52
    v_lshlrev_b32 v30, 16, v30
    v_sub_f32 v31, v52, v30
    v_cvt_pk_bf16_f32 v32, v52, v31
    v_and_b32 v30, 0xffff0000, v32
    v_sub_f32 v31, v31, v30
    v_cvt_pk_bf16_f32 v33, v31, 0
    v_and_b32 v30, 15, v0
    v_lshlrev_b32 v30, 3, v30
    v_add_u32 v30, s70, v30
    s_mov_b64 exec, 0xffff
    ds_write_b64 v30, v[32:33]
    s_mov_b64 exec, -1
    s_waitcnt lgkmcnt(0)
    s_lshl_b32 s62, s52, 15
    s_lshl_b32 s63, s22, 11
    s_add_u32 s62, s62, s63
    s_add_u32 s62, s62, 720896
    buffer_load_dword v8, v1, s[28:31], s62 offen offset:0
    buffer_load_dword v8, v1, s[28:31], s62 offen offset:1024
    s_lshl_b32 s62, s2, 2
    s_add_u32 s62, s62, s52
    s_mul_i32 s62, s62, 1024
    buffer_load_dword v8, v1, s[36:39], s62 offen offset:0
    s_lshl_b32 s62, s2, 2
    s_add_u32 s62, s62, s52
    s_mul_i32 s62, s62, 2048
    buffer_load_dword v8, v1, s[40:43], s62 offen offset:0
    buffer_load_dword v8, v1, s[40:43], s62 offen offset:1024
    s_lshl_b32 s62, s2, 2
    s_add_u32 s62, s62, s52
    s_mul_i32 s62, s62, 2048
    buffer_load_dword v8, v1, s[44:47], s62 offen offset:0
    buffer_load_dword v8, v1, s[44:47], s62 offen offset:1024
    s_lshl_b32 s62, s2, 2
    s_add_u32 s62, s62, s52
    s_mul_i32 s62, s62, 2048
    buffer_load_dword v8, v1, s[48:51], s62 offen offset:0
    buffer_load_dword v8, v1, s[48:51], s62 offen offset:1024
    s_lshl_b32 s79, s22, 2
    s_add_u32 s79, s79, s52
    s_lshl_b32 s79, s79, 9
    s_add_u32 s79, s79, s76
    s_add_u32 s79, s79, 256
    s_add_u32 s82, s18, s79
    s_addc_u32 s83, s19, 0
    s_load_dword s84, s[82:83], 0
    s_load_dword s84, s[82:83], 64
    s_load_dword s84, s[82:83], 128
    s_load_dword s84, s[82:83], 192
    s_lshl_b32 s79, s22, 1
    s_and_b32 s74, s52, 1
    s_add_u32 s79, s79, s74
    s_lshr_b32 s74, s79, 2
    s_lshl_b32 s74, s74, 9
    s_and_b32 s79, s79, 3
    s_lshl_b32 s79, s79, 6
    s_add_u32 s79, s79, s74
    s_add_u32 s79, s79, s77
    s_add_u32 s79, s79, 256
    s_add_u32 s86, s18, s79
    s_addc_u32 s87, s19, 0
    s_load_dword s85, s[86:87], 0
    s_barrier
    s_waitcnt lgkmcnt(0)
    buffer_load_dwordx4 v[224:227], v11, s[28:31], s76 offen offset:0 sc1
    buffer_load_dwordx4 v[228:231], v11, s[28:31], s76 offen offset:2048 sc1
    s_add_u32 s76, s76, 4096
    buffer_load_dwordx4 v[232:235], v11, s[28:31], s76 offen offset:0 sc1
    buffer_load_dwordx4 v[236:239], v11, s[28:31], s76 offen offset:2048 sc1
    s_add_u32 s76, s76, 4096
    buffer_load_dwordx4 v[240:243], v11, s[28:31], s76 offen offset:0 sc1
    buffer_load_dwordx4 v[244:247], v11, s[28:31], s76 offen offset:2048 sc1
    s_add_u32 s76, s76, 4096
    buffer_load_dwordx4 v[248:251], v11, s[28:31], s76 offen offset:0 sc1
    buffer_load_dwordx4 v[252:255], v11, s[28:31], s76 offen offset:2048 sc1
    s_waitcnt vmcnt(7)
    v_mfma_f32_16x16x32_bf16 v[56:59], v[160:163], v[224:227], 0
    s_add_u32 s76, s76, 4096
    buffer_load_dwordx4 v[224:227], v11, s[28:31], s76 offen offset:0 sc1
    s_waitcnt vmcnt(7)
    v_mfma_f32_16x16x32_bf16 v[56:59], v[164:167], v[228:231], v[56:59]
    buffer_load_dwordx4 v[228:231], v11, s[28:31], s76 offen offset:2048 sc1
    s_waitcnt vmcnt(7)
    v_mfma_f32_16x16x32_bf16 v[56:59], v[168:171], v[232:235], v[56:59]
    s_add_u32 s76, s76, 4096
    buffer_load_dwordx4 v[232:235], v11, s[28:31], s76 offen offset:0 sc1
    s_waitcnt vmcnt(7)
    v_mfma_f32_16x16x32_bf16 v[56:59], v[172:175], v[236:239], v[56:59]
    buffer_load_dwordx4 v[236:239], v11, s[28:31], s76 offen offset:2048 sc1
    s_waitcnt vmcnt(7)
    v_mfma_f32_16x16x32_bf16 v[56:59], v[176:179], v[240:243], v[56:59]
    s_add_u32 s76, s76, 4096
    buffer_load_dwordx4 v[240:243], v11, s[28:31], s76 offen offset:0 sc1
    s_waitcnt vmcnt(7)
    v_mfma_f32_16x16x32_bf16 v[56:59], v[180:183], v[244:247], v[56:59]
    buffer_load_dwordx4 v[244:247], v11, s[28:31], s76 offen offset:2048 sc1
    s_waitcnt vmcnt(7)
    v_mfma_f32_16x16x32_bf16 v[56:59], v[184:187], v[248:251], v[56:59]
    s_add_u32 s76, s76, 4096
    buffer_load_dwordx4 v[248:251], v11, s[28:31], s76 offen offset:0 sc1
    s_waitcnt vmcnt(7)
    v_mfma_f32_16x16x32_bf16 v[56:59], v[188:191], v[252:255], v[56:59]
    buffer_load_dwordx4 v[252:255], v11, s[28:31], s76 offen offset:2048 sc1
    buffer_load_dwordx4 v[160:163], v16, s[28:31], s77 offen offset:0 sc1
    buffer_load_dwordx4 v[164:167], v16, s[28:31], s77 offen offset:512 sc1
    buffer_load_dwordx4 v[168:171], v16, s[28:31], s77 offen offset:1024 sc1
    buffer_load_dwordx4 v[172:175], v16, s[28:31], s77 offen offset:1536 sc1
    buffer_load_dwordx4 v[176:179], v16, s[28:31], s77 offen offset:2048 sc1
    buffer_load_dwordx4 v[180:183], v16, s[28:31], s77 offen offset:2560 sc1
    buffer_load_dwordx4 v[184:187], v16, s[28:31], s77 offen offset:3072 sc1
    buffer_load_dwordx4 v[188:191], v16, s[28:31], s77 offen offset:3584 sc1
    s_waitcnt vmcnt(15)
    v_mfma_f32_16x16x32_bf16 v[56:59], v[192:195], v[224:227], v[56:59]
    s_waitcnt vmcnt(14)
    v_mfma_f32_16x16x32_bf16 v[56:59], v[196:199], v[228:231], v[56:59]
    s_waitcnt vmcnt(13)
    v_mfma_f32_16x16x32_bf16 v[56:59], v[200:203], v[232:235], v[56:59]
    s_waitcnt vmcnt(12)
    v_mfma_f32_16x16x32_bf16 v[56:59], v[204:207], v[236:239], v[56:59]
    s_waitcnt vmcnt(11)
    v_mfma_f32_16x16x32_bf16 v[56:59], v[208:211], v[240:243], v[56:59]
    s_waitcnt vmcnt(10)
    v_mfma_f32_16x16x32_bf16 v[56:59], v[212:215], v[244:247], v[56:59]
    s_waitcnt vmcnt(9)
    v_mfma_f32_16x16x32_bf16 v[56:59], v[216:219], v[248:251], v[56:59]
    s_waitcnt vmcnt(8)
    v_mfma_f32_16x16x32_bf16 v[56:59], v[220:223], v[252:255], v[56:59]
    s_waitcnt vmcnt(0)
    v_add_f32 v160, v160, v162
    v_add_f32 v164, v164, v166
    v_add_f32 v168, v168, v170
    v_add_f32 v172, v172, v174
    v_add_f32 v176, v176, v178
    v_add_f32 v180, v180, v182
    v_add_f32 v184, v184, v186
    v_add_f32 v188, v188, v190
    v_add_f32 v160, v160, v164
    v_add_f32 v168, v168, v172
    v_add_f32 v176, v176, v180
    v_add_f32 v184, v184, v188
    v_add_f32 v160, v160, v168
    v_add_f32 v176, v176, v184
    v_add_f32 v160, v160, v176
    v_add_f32 v161, v161, v163
    v_add_f32 v165, v165, v167
    v_add_f32 v169, v169, v171
    v_add_f32 v173, v173, v175
    v_add_f32 v177, v177, v179
    v_add_f32 v181, v181, v183
    v_add_f32 v185, v185, v187
    v_add_f32 v189, v189, v191
    v_add_f32 v161, v161, v165
    v_add_f32 v169, v169, v173
    v_add_f32 v177, v177, v181
    v_add_f32 v185, v185, v189
    v_add_f32 v161, v161, v169
    v_add_f32 v177, v177, v185
    v_add_f32 v161, v161, v177
    v_mul_f32 v30, 0x3b000000, v160
    v_mul_f32 v31, 0x3b000000, v161
    v_fma_f32 v31, -v30, v30, v31
    v_max_f32 v31, 0, v31
    v_cvt_pk_bf16_f32 v32, v30, v30
    v_cvt_pk_bf16_f32 v31, v31, v31
    v_xor_b32 v20, 0x80008000, v32
    v_and_b32 v31, 0xffff0000, v31
    v_and_b32 v21, 0xffff, v20
    v_add_f32 v31, 0x3727c5ac, v31
    v_cvt_pk_bf16_f32 v31, v31, v31
    v_and_b32 v31, 0xffff0000, v31
    v_sqrt_f32 v31, v31
    s_nop 0
    v_cvt_pk_bf16_f32 v31, v31, v31
    v_and_b32 v31, 0xffff0000, v31
    v_rcp_f32 v34, v31
    ds_read_b64 v[24:25], v17
    s_waitcnt lgkmcnt(0)
    v_mfma_f32_16x16x32_bf16 v[56:59], v[24:27], v[20:23], v[56:59]
    s_nop 7
    v_mul_f32 v56, v56, v34
    v_mul_f32 v57, v57, v34
    v_mul_f32 v58, v58, v34
    v_mul_f32 v59, v59, v34
    s_cmp_ge_u32 s52, 2
    s_cbranch_scc1 Lhv_H_1
    v_cvt_pk_bf16_f32 v30, v56, v57
    v_cvt_pk_bf16_f32 v31, v58, v59
    ds_write_b64 v19, v[30:31]
    s_branch Lhd_H_2
Lhv_H_1:
    ds_write_b128 v28, v[56:59]
Lhd_H_2:
    s_waitcnt lgkmcnt(0)
    s_barrier
    s_add_u32 s62, s56, s59
    s_add_u32 s62, s62, 0
    s_add_u32 m0, s61, 98304
    s_nop 0
    buffer_load_dwordx4 v5, s[36:39], s62 offen lds
    s_add_u32 s62, s62, 8192
    s_add_u32 m0, m0, 1024
    s_nop 0
    buffer_load_dwordx4 v5, s[36:39], s62 offen lds
    s_add_u32 s62, s62, 8192
    s_add_u32 m0, m0, 1024
    s_nop 0
    buffer_load_dwordx4 v5, s[36:39], s62 offen lds
    s_add_u32 s62, s62, 8192
    s_add_u32 m0, m0, 1024
    s_nop 0
    buffer_load_dwordx4 v5, s[36:39], s62 offen lds
    s_add_u32 s62, s56, s59
    s_add_u32 s62, s62, 131072
    s_add_u32 m0, s61, 114688
    s_nop 0
    buffer_load_dwordx4 v5, s[36:39], s62 offen lds
    s_add_u32 s62, s62, 8192
    s_add_u32 m0, m0, 1024
    s_nop 0
    buffer_load_dwordx4 v5, s[36:39], s62 offen lds
    s_add_u32 s62, s62, 8192
    s_add_u32 m0, m0, 1024
    s_nop 0
    buffer_load_dwordx4 v5, s[36:39], s62 offen lds
    s_add_u32 s62, s62, 8192
    s_add_u32 m0, m0, 1024
    s_nop 0
    buffer_load_dwordx4 v5, s[36:39], s62 offen lds
    s_add_u32 s62, s56, s59
    s_add_u32 s62, s62, 262144
    s_add_u32 m0, s61, 0
    s_nop 0
    buffer_load_dwordx4 v5, s[36:39], s62 offen lds
    s_add_u32 s62, s62, 8192
    s_add_u32 m0, m0, 1024
    s_nop 0
    buffer_load_dwordx4 v5, s[36:39], s62 offen lds
    s_add_u32 s62, s62, 8192
    s_add_u32 m0, m0, 1024
    s_nop 0
    buffer_load_dwordx4 v5, s[36:39], s62 offen lds
    s_add_u32 s62, s62, 8192
    s_add_u32 m0, m0, 1024
    s_nop 0
    buffer_load_dwordx4 v5, s[36:39], s62 offen lds
    s_add_u32 s62, s56, s59
    s_add_u32 s62, s62, 393216
    s_add_u32 m0, s61, 16384
    s_nop 0
    buffer_load_dwordx4 v5, s[36:39], s62 offen lds
    s_add_u32 s62, s62, 8192
    s_add_u32 m0, m0, 1024
    s_nop 0
    buffer_load_dwordx4 v5, s[36:39], s62 offen lds
    s_add_u32 s62, s62, 8192
    s_add_u32 m0, m0, 1024
    s_nop 0
    buffer_load_dwordx4 v5, s[36:39], s62 offen lds
    s_add_u32 s62, s62, 8192
    s_add_u32 m0, m0, 1024
    s_nop 0
    buffer_load_dwordx4 v5, s[36:39], s62 offen lds
    s_add_u32 s62, s52, 0
    s_mul_i32 s63, s62, 0x5556
    s_lshr_b32 s63, s63, 16
    s_mul_i32 s63, s63, 44032
    s_add_u32 s63, s63, s57
    s_add_u32 s63, s63, 0
    s_lshl_b32 s62, s62, 10
    s_add_u32 m0, s62, 32768
    s_nop 0
    buffer_load_dwordx4 v6, s[40:43], s63 offen lds
    s_add_u32 s62, s52, 4
    s_mul_i32 s63, s62, 0x5556
    s_lshr_b32 s63, s63, 16
    s_mul_i32 s63, s63, 44032
    s_add_u32 s63, s63, s57
    s_add_u32 s63, s63, 0
    s_lshl_b32 s62, s62, 10
    s_add_u32 m0, s62, 32768
    s_nop 0
    buffer_load_dwordx4 v10, s[40:43], s63 offen lds
    s_add_u32 s62, s52, 8
    s_mul_i32 s63, s62, 0x5556
    s_lshr_b32 s63, s63, 16
    s_mul_i32 s63, s63, 44032
    s_add_u32 s63, s63, s57
    s_add_u32 s63, s63, 0
    s_lshl_b32 s62, s62, 10
    s_add_u32 m0, s62, 32768
    s_nop 0
    buffer_load_dwordx4 v18, s[40:43], s63 offen lds
    s_add_u32 s62, s52, 12
    s_sub_u32 s63, s62, 3
    s_cmp_ge_u32 s62, 15
    s_cselect_b32 s62, s63, s62
    s_mul_i32 s63, s62, 0x5556
    s_lshr_b32 s63, s63, 16
    s_mul_i32 s63, s63, 44032
    s_add_u32 s63, s63, s57
    s_add_u32 s63, s63, 0
    s_lshl_b32 s62, s62, 10
    s_add_u32 m0, s62, 32768
    s_nop 0
    buffer_load_dwordx4 v6, s[40:43], s63 offen lds
    s_add_u32 s62, s52, 0
    s_mul_i32 s63, s62, 0x5556
    s_lshr_b32 s63, s63, 16
    s_mul_i32 s63, s63, 44032
    s_add_u32 s63, s63, s57
    s_add_u32 s63, s63, 0
    s_lshl_b32 s62, s62, 10
    s_add_u32 m0, s62, 49152
    s_nop 0
    buffer_load_dwordx4 v6, s[44:47], s63 offen lds
    s_add_u32 s62, s52, 4
    s_mul_i32 s63, s62, 0x5556
    s_lshr_b32 s63, s63, 16
    s_mul_i32 s63, s63, 44032
    s_add_u32 s63, s63, s57
    s_add_u32 s63, s63, 0
    s_lshl_b32 s62, s62, 10
    s_add_u32 m0, s62, 49152
    s_nop 0
    buffer_load_dwordx4 v10, s[44:47], s63 offen lds
    s_add_u32 s62, s52, 8
    s_mul_i32 s63, s62, 0x5556
    s_lshr_b32 s63, s63, 16
    s_mul_i32 s63, s63, 44032
    s_add_u32 s63, s63, s57
    s_add_u32 s63, s63, 0
    s_lshl_b32 s62, s62, 10
    s_add_u32 m0, s62, 49152
    s_nop 0
    buffer_load_dwordx4 v18, s[44:47], s63 offen lds
    s_add_u32 s62, s52, 12
    s_sub_u32 s63, s62, 3
    s_cmp_ge_u32 s62, 15
    s_cselect_b32 s62, s63, s62
    s_mul_i32 s63, s62, 0x5556
    s_lshr_b32 s63, s63, 16
    s_mul_i32 s63, s63, 44032
    s_add_u32 s63, s63, s57
    s_add_u32 s63, s63, 0
    s_lshl_b32 s62, s62, 10
    s_add_u32 m0, s62, 49152
    s_nop 0
    buffer_load_dwordx4 v6, s[44:47], s63 offen lds
    s_waitcnt vmcnt(8)
    s_barrier
    s_barrier
    s_add_u32 s62, s52, 0
    s_mul_i32 s63, s62, 0x5556
    s_lshr_b32 s63, s63, 16
    s_mul_i32 s63, s63, 44032
    s_add_u32 s63, s63, s57
    s_add_u32 s63, s63, 220160
    s_lshl_b32 s62, s62, 10
    s_add_u32 m0, s62, 65536
    s_nop 0
    buffer_load_dwordx4 v6, s[40:43], s63 offen lds
    s_add_u32 s62, s52, 4
    s_mul_i32 s63, s62, 0x5556
    s_lshr_b32 s63, s63, 16
    s_mul_i32 s63, s63, 44032
    s_add_u32 s63, s63, s57
    s_add_u32 s63, s63, 220160
    s_lshl_b32 s62, s62, 10
    s_add_u32 m0, s62, 65536
    s_nop 0
    buffer_load_dwordx4 v10, s[40:43], s63 offen lds
    s_add_u32 s62, s52, 8
    s_mul_i32 s63, s62, 0x5556
    s_lshr_b32 s63, s63, 16
    s_mul_i32 s63, s63, 44032
    s_add_u32 s63, s63, s57
    s_add_u32 s63, s63, 220160
    s_lshl_b32 s62, s62, 10
    s_add_u32 m0, s62, 65536
    s_nop 0
    buffer_load_dwordx4 v18, s[40:43], s63 offen lds
    s_add_u32 s62, s52, 12
    s_sub_u32 s63, s62, 3
    s_cmp_ge_u32 s62, 15
    s_cselect_b32 s62, s63, s62
    s_mul_i32 s63, s62, 0x5556
    s_lshr_b32 s63, s63, 16
    s_mul_i32 s63, s63, 44032
    s_add_u32 s63, s63, s57
    s_add_u32 s63, s63, 220160
    s_lshl_b32 s62, s62, 10
    s_add_u32 m0, s62, 65536
    s_nop 0
    buffer_load_dwordx4 v6, s[40:43], s63 offen lds
    s_add_u32 s62, s52, 0
    s_mul_i32 s63, s62, 0x5556
    s_lshr_b32 s63, s63, 16
    s_mul_i32 s63, s63, 44032
    s_add_u32 s63, s63, s57
    s_add_u32 s63, s63, 220160
    s_lshl_b32 s62, s62, 10
    s_add_u32 m0, s62, 81920
    s_nop 0
    buffer_load_dwordx4 v6, s[44:47], s63 offen lds
    s_add_u32 s62, s52, 4
    s_mul_i32 s63, s62, 0x5556
    s_lshr_b32 s63, s63, 16
    s_mul_i32 s63, s63, 44032
    s_add_u32 s63, s63, s57
    s_add_u32 s63, s63, 220160
    s_lshl_b32 s62, s62, 10
    s_add_u32 m0, s62, 81920
    s_nop 0
    buffer_load_dwordx4 v10, s[44:47], s63 offen lds
    s_add_u32 s62, s52, 8
    s_mul_i32 s63, s62, 0x5556
    s_lshr_b32 s63, s63, 16
    s_mul_i32 s63, s63, 44032
    s_add_u32 s63, s63, s57
    s_add_u32 s63, s63, 220160
    s_lshl_b32 s62, s62, 10
    s_add_u32 m0, s62, 81920
    s_nop 0
    buffer_load_dwordx4 v18, s[44:47], s63 offen lds
    s_add_u32 s62, s52, 12
    s_sub_u32 s63, s62, 3
    s_cmp_ge_u32 s62, 15
    s_cselect_b32 s62, s63, s62
    s_mul_i32 s63, s62, 0x5556
    s_lshr_b32 s63, s63, 16
    s_mul_i32 s63, s63, 44032
    s_add_u32 s63, s63, s57
    s_add_u32 s63, s63, 220160
    s_lshl_b32 s62, s62, 10
    s_add_u32 m0, s62, 81920
    s_nop 0
    buffer_load_dwordx4 v6, s[44:47], s63 offen lds
    s_add_u32 s62, s52, 0
    s_mul_i32 s63, s62, 0x5556
    s_lshr_b32 s63, s63, 16
    s_mul_i32 s63, s63, 44032
    s_add_u32 s63, s63, s57
    s_add_u32 s63, s63, 440320
    buffer_load_dwordx4 v[160:163], v6, s[40:43], s63 offen
    s_add_u32 s62, s52, 4
    s_mul_i32 s63, s62, 0x5556
    s_lshr_b32 s63, s63, 16
    s_mul_i32 s63, s63, 44032
    s_add_u32 s63, s63, s57
    s_add_u32 s63, s63, 440320
    buffer_load_dwordx4 v[164:167], v10, s[40:43], s63 offen
    s_add_u32 s62, s52, 8
    s_mul_i32 s63, s62, 0x5556
    s_lshr_b32 s63, s63, 16
    s_mul_i32 s63, s63, 44032
    s_add_u32 s63, s63, s57
    s_add_u32 s63, s63, 440320
    buffer_load_dwordx4 v[168:171], v18, s[40:43], s63 offen
    s_add_u32 s62, s52, 12
    s_sub_u32 s63, s62, 3
    s_cmp_ge_u32 s62, 15
    s_cselect_b32 s62, s63, s62
    s_mul_i32 s63, s62, 0x5556
    s_lshr_b32 s63, s63, 16
    s_mul_i32 s63, s63, 44032
    s_add_u32 s63, s63, s57
    s_add_u32 s63, s63, 440320
    buffer_load_dwordx4 v[172:175], v6, s[40:43], s63 offen
    s_add_u32 s62, s52, 0
    s_mul_i32 s63, s62, 0x5556
    s_lshr_b32 s63, s63, 16
    s_mul_i32 s63, s63, 44032
    s_add_u32 s63, s63, s57
    s_add_u32 s63, s63, 440320
    buffer_load_dwordx4 v[176:179], v6, s[44:47], s63 offen
    s_add_u32 s62, s52, 4
    s_mul_i32 s63, s62, 0x5556
    s_lshr_b32 s63, s63, 16
    s_mul_i32 s63, s63, 44032
    s_add_u32 s63, s63, s57
    s_add_u32 s63, s63, 440320
    buffer_load_dwordx4 v[180:183], v10, s[44:47], s63 offen
    s_add_u32 s62, s52, 8
    s_mul_i32 s63, s62, 0x5556
    s_lshr_b32 s63, s63, 16
    s_mul_i32 s63, s63, 44032
    s_add_u32 s63, s63, s57
    s_add_u32 s63, s63, 440320
    buffer_load_dwordx4 v[184:187], v18, s[44:47], s63 offen
    s_add_u32 s62, s52, 12
    s_sub_u32 s63, s62, 3
    s_cmp_ge_u32 s62, 15
    s_cselect_b32 s62, s63, s62
    s_mul_i32 s63, s62, 0x5556
    s_lshr_b32 s63, s63, 16
    s_mul_i32 s63, s63, 44032
    s_add_u32 s63, s63, s57
    s_add_u32 s63, s63, 440320
    buffer_load_dwordx4 v[188:191], v6, s[44:47], s63 offen
    s_add_u32 s62, s52, 0
    s_mul_i32 s63, s62, 0x5556
    s_lshr_b32 s63, s63, 16
    s_mul_i32 s63, s63, 44032
    s_add_u32 s63, s63, s57
    s_add_u32 s63, s63, 660480
    buffer_load_dwordx4 v[192:195], v6, s[40:43], s63 offen
    s_add_u32 s62, s52, 4
    s_mul_i32 s63, s62, 0x5556
    s_lshr_b32 s63, s63, 16
    s_mul_i32 s63, s63, 44032
    s_add_u32 s63, s63, s57
    s_add_u32 s63, s63, 660480
    buffer_load_dwordx4 v[196:199], v10, s[40:43], s63 offen
    s_add_u32 s62, s52, 8
    s_mul_i32 s63, s62, 0x5556
    s_lshr_b32 s63, s63, 16
    s_mul_i32 s63, s63, 44032
    s_add_u32 s63, s63, s57
    s_add_u32 s63, s63, 660480
    buffer_load_dwordx4 v[200:203], v18, s[40:43], s63 offen
    s_add_u32 s62, s52, 12
    s_sub_u32 s63, s62, 3
    s_cmp_ge_u32 s62, 15
    s_cselect_b32 s62, s63, s62
    s_mul_i32 s63, s62, 0x5556
    s_lshr_b32 s63, s63, 16
    s_mul_i32 s63, s63, 44032
    s_add_u32 s63, s63, s57
    s_add_u32 s63, s63, 660480
    buffer_load_dwordx4 v[204:207], v6, s[40:43], s63 offen
    s_add_u32 s62, s52, 0
    s_mul_i32 s63, s62, 0x5556
    s_lshr_b32 s63, s63, 16
    s_mul_i32 s63, s63, 44032
    s_add_u32 s63, s63, s57
    s_add_u32 s63, s63, 660480
    buffer_load_dwordx4 v[208:211], v6, s[44:47], s63 offen
    s_add_u32 s62, s52, 4
    s_mul_i32 s63, s62, 0x5556
    s_lshr_b32 s63, s63, 16
    s_mul_i32 s63, s63, 44032
    s_add_u32 s63, s63, s57
    s_add_u32 s63, s63, 660480
    buffer_load_dwordx4 v[212:215], v10, s[44:47], s63 offen
    s_add_u32 s62, s52, 8
    s_mul_i32 s63, s62, 0x5556
    s_lshr_b32 s63, s63, 16
    s_mul_i32 s63, s63, 44032
    s_add_u32 s63, s63, s57
    s_add_u32 s63, s63, 660480
    buffer_load_dwordx4 v[216:219], v18, s[44:47], s63 offen
    s_add_u32 s62, s52, 12
    s_sub_u32 s63, s62, 3
    s_cmp_ge_u32 s62, 15
    s_cselect_b32 s62, s63, s62
    s_mul_i32 s63, s62, 0x5556
    s_lshr_b32 s63, s63, 16
    s_mul_i32 s63, s63, 44032
    s_add_u32 s63, s63, s57
    s_add_u32 s63, s63, 660480
    buffer_load_dwordx4 v[220:223], v6, s[44:47], s63 offen
    s_barrier
    s_waitcnt vmcnt(16)
    s_barrier
    s_cmp_lt_u32 s52, 2
    s_mov_b32 s69, 32768
    s_cselect_b32 s69, s69, 49152
    v_lshrrev_b32 v35, 2, v0
    v_mul_u32_u24 v29, 192, v35
    v_and_b32 v35, 3, v0
    v_lshl_add_u32 v29, v35, 3, v29
    s_add_u32 s69, s69, s65
    v_add_u32 v29, s69, v29
    ds_read_b64_tr_b16 v[36:37], v29 offset:0
    ds_read_b64_tr_b16 v[38:39], v29 offset:64
    ds_read_b64_tr_b16 v[40:41], v29 offset:128
    ds_read_b64_tr_b16 v[42:43], v29 offset:3072
    ds_read_b64_tr_b16 v[44:45], v29 offset:3136
    ds_read_b64_tr_b16 v[46:47], v29 offset:3200
    ds_read_b64_tr_b16 v[48:49], v29 offset:6144
    ds_read_b64_tr_b16 v[50:51], v29 offset:6208
    s_waitcnt lgkmcnt(7)
    v_mfma_f32_16x16x16_bf16 v[52:55], v[12:13], v[36:37], 0
    ds_read_b64_tr_b16 v[36:37], v29 offset:6272
    s_waitcnt lgkmcnt(7)
    v_mfma_f32_16x16x16_bf16 v[56:59], v[12:13], v[38:39], 0
    ds_read_b64_tr_b16 v[38:39], v29 offset:9216
    s_waitcnt lgkmcnt(7)
    v_mfma_f32_16x16x16_bf16 v[60:63], v[12:13], v[40:41], 0
    ds_read_b64_tr_b16 v[40:41], v29 offset:9280
    s_waitcnt lgkmcnt(7)
    v_mfma_f32_16x16x16_bf16 v[52:55], v[12:13], v[42:43], v[52:55]
    ds_read_b64_tr_b16 v[42:43], v29 offset:9344
    s_waitcnt lgkmcnt(7)
    v_mfma_f32_16x16x16_bf16 v[56:59], v[12:13], v[44:45], v[56:59]
    ds_read_b64_tr_b16 v[44:45], v29 offset:12288
    s_waitcnt lgkmcnt(7)
    v_mfma_f32_16x16x16_bf16 v[60:63], v[12:13], v[46:47], v[60:63]
    ds_read_b64_tr_b16 v[46:47], v29 offset:12352
    s_waitcnt lgkmcnt(7)
    v_mfma_f32_16x16x16_bf16 v[52:55], v[12:13], v[48:49], v[52:55]
    ds_read_b64_tr_b16 v[48:49], v29 offset:12416
    s_waitcnt lgkmcnt(7)
    v_mfma_f32_16x16x16_bf16 v[56:59], v[12:13], v[50:51], v[56:59]
    s_waitcnt lgkmcnt(6)
    v_mfma_f32_16x16x16_bf16 v[60:63], v[12:13], v[36:37], v[60:63]
    s_waitcnt lgkmcnt(5)
    v_mfma_f32_16x16x16_bf16 v[52:55], v[12:13], v[38:39], v[52:55]
    s_waitcnt lgkmcnt(4)
    v_mfma_f32_16x16x16_bf16 v[56:59], v[12:13], v[40:41], v[56:59]
    s_waitcnt lgkmcnt(3)
    v_mfma_f32_16x16x16_bf16 v[60:63], v[12:13], v[42:43], v[60:63]
    s_waitcnt lgkmcnt(2)
    v_mfma_f32_16x16x16_bf16 v[52:55], v[12:13], v[44:45], v[52:55]
    s_waitcnt lgkmcnt(1)
    v_mfma_f32_16x16x16_bf16 v[56:59], v[12:13], v[46:47], v[56:59]
    s_waitcnt lgkmcnt(0)
    v_mfma_f32_16x16x16_bf16 v[60:63], v[12:13], v[48:49], v[60:63]
    s_cmp_lt_u32 s52, 2
    s_mov_b32 s69, 65536
    s_cselect_b32 s69, s69, 81920
    v_lshrrev_b32 v35, 2, v0
    v_mul_u32_u24 v29, 192, v35
    v_and_b32 v35, 3, v0
    v_lshl_add_u32 v29, v35, 3, v29
    s_add_u32 s69, s69, s65
    v_add_u32 v29, s69, v29
    ds_read_b64_tr_b16 v[36:37], v29 offset:0
    ds_read_b64_tr_b16 v[38:39], v29 offset:64
    ds_read_b64_tr_b16 v[40:41], v29 offset:128
    ds_read_b64_tr_b16 v[42:43], v29 offset:3072
    ds_read_b64_tr_b16 v[44:45], v29 offset:3136
    ds_read_b64_tr_b16 v[46:47], v29 offset:3200
    ds_read_b64_tr_b16 v[48:49], v29 offset:6144
    ds_read_b64_tr_b16 v[50:51], v29 offset:6208
    s_waitcnt lgkmcnt(7)
    v_mfma_f32_16x16x16_bf16 v[52:55], v[12:13], v[36:37], v[52:55]
    ds_read_b64_tr_b16 v[36:37], v29 offset:6272
    s_waitcnt lgkmcnt(7)
    v_mfma_f32_16x16x16_bf16 v[56:59], v[12:13], v[38:39], v[56:59]
    ds_read_b64_tr_b16 v[38:39], v29 offset:9216
    s_waitcnt lgkmcnt(7)
    v_mfma_f32_16x16x16_bf16 v[60:63], v[12:13], v[40:41], v[60:63]
    ds_read_b64_tr_b16 v[40:41], v29 offset:9280
    s_waitcnt lgkmcnt(7)
    v_mfma_f32_16x16x16_bf16 v[52:55], v[12:13], v[42:43], v[52:55]
    ds_read_b64_tr_b16 v[42:43], v29 offset:9344
    s_waitcnt lgkmcnt(7)
    v_mfma_f32_16x16x16_bf16 v[56:59], v[12:13], v[44:45], v[56:59]
    ds_read_b64_tr_b16 v[44:45], v29 offset:12288
    s_waitcnt lgkmcnt(7)
    v_mfma_f32_16x16x16_bf16 v[60:63], v[12:13], v[46:47], v[60:63]
    ds_read_b64_tr_b16 v[46:47], v29 offset:12352
    s_waitcnt lgkmcnt(7)
    v_mfma_f32_16x16x16_bf16 v[52:55], v[12:13], v[48:49], v[52:55]
    ds_read_b64_tr_b16 v[48:49], v29 offset:12416
    s_waitcnt lgkmcnt(7)
    v_mfma_f32_16x16x16_bf16 v[56:59], v[12:13], v[50:51], v[56:59]
    s_waitcnt lgkmcnt(6)
    v_mfma_f32_16x16x16_bf16 v[60:63], v[12:13], v[36:37], v[60:63]
    s_waitcnt lgkmcnt(5)
    v_mfma_f32_16x16x16_bf16 v[52:55], v[12:13], v[38:39], v[52:55]
    s_waitcnt lgkmcnt(4)
    v_mfma_f32_16x16x16_bf16 v[56:59], v[12:13], v[40:41], v[56:59]
    s_waitcnt lgkmcnt(3)
    v_mfma_f32_16x16x16_bf16 v[60:63], v[12:13], v[42:43], v[60:63]
    s_waitcnt lgkmcnt(2)
    v_mfma_f32_16x16x16_bf16 v[52:55], v[12:13], v[44:45], v[52:55]
    s_waitcnt lgkmcnt(1)
    v_mfma_f32_16x16x16_bf16 v[56:59], v[12:13], v[46:47], v[56:59]
    s_waitcnt lgkmcnt(0)
    v_mfma_f32_16x16x16_bf16 v[60:63], v[12:13], v[48:49], v[60:63]
    s_waitcnt vmcnt(12)
    s_add_u32 s62, s52, 0
    s_lshl_b32 s62, s62, 10
    s_add_u32 s62, s62, 98304
    v_add_u32 v2, s62, v1
    ds_write_b128 v2, v[160:163]
    s_add_u32 s62, s52, 4
    s_lshl_b32 s62, s62, 10
    s_add_u32 s62, s62, 98304
    v_add_u32 v2, s62, v1
    ds_write_b128 v2, v[164:167]
    s_add_u32 s62, s52, 8
    s_lshl_b32 s62, s62, 10
    s_add_u32 s62, s62, 98304
    v_add_u32 v2, s62, v1
    ds_write_b128 v2, v[168:171]
    s_add_u32 s62, s52, 12
    s_sub_u32 s63, s62, 3
    s_cmp_ge_u32 s62, 15
    s_cselect_b32 s62, s63, s62
    s_lshl_b32 s62, s62, 10
    s_add_u32 s62, s62, 98304
    v_add_u32 v2, s62, v1
    ds_write_b128 v2, v[172:175]
    s_waitcnt vmcnt(8)
    s_add_u32 s62, s52, 0
    s_lshl_b32 s62, s62, 10
    s_add_u32 s62, s62, 114688
    v_add_u32 v2, s62, v1
    ds_write_b128 v2, v[176:179]
    s_add_u32 s62, s52, 4
    s_lshl_b32 s62, s62, 10
    s_add_u32 s62, s62, 114688
    v_add_u32 v2, s62, v1
    ds_write_b128 v2, v[180:183]
    s_add_u32 s62, s52, 8
    s_lshl_b32 s62, s62, 10
    s_add_u32 s62, s62, 114688
    v_add_u32 v2, s62, v1
    ds_write_b128 v2, v[184:187]
    s_add_u32 s62, s52, 12
    s_sub_u32 s63, s62, 3
    s_cmp_ge_u32 s62, 15
    s_cselect_b32 s62, s63, s62
    s_lshl_b32 s62, s62, 10
    s_add_u32 s62, s62, 114688
    v_add_u32 v2, s62, v1
    ds_write_b128 v2, v[188:191]
    s_waitcnt lgkmcnt(0)
    s_barrier
    s_add_u32 s62, s52, 0
    s_mul_i32 s63, s62, 0x5556
    s_lshr_b32 s63, s63, 16
    s_mul_i32 s63, s63, 44032
    s_add_u32 s63, s63, s57
    s_add_u32 s63, s63, 880640
    s_lshl_b32 s62, s62, 10
    s_add_u32 m0, s62, 32768
    s_nop 0
    buffer_load_dwordx4 v6, s[40:43], s63 offen lds
    s_add_u32 s62, s52, 4
    s_mul_i32 s63, s62, 0x5556
    s_lshr_b32 s63, s63, 16
    s_mul_i32 s63, s63, 44032
    s_add_u32 s63, s63, s57
    s_add_u32 s63, s63, 880640
    s_lshl_b32 s62, s62, 10
    s_add_u32 m0, s62, 32768
    s_nop 0
    buffer_load_dwordx4 v10, s[40:43], s63 offen lds
    s_add_u32 s62, s52, 8
    s_mul_i32 s63, s62, 0x5556
    s_lshr_b32 s63, s63, 16
    s_mul_i32 s63, s63, 44032
    s_add_u32 s63, s63, s57
    s_add_u32 s63, s63, 880640
    s_lshl_b32 s62, s62, 10
    s_add_u32 m0, s62, 32768
    s_nop 0
    buffer_load_dwordx4 v18, s[40:43], s63 offen lds
    s_add_u32 s62, s52, 12
    s_sub_u32 s63, s62, 3
    s_cmp_ge_u32 s62, 15
    s_cselect_b32 s62, s63, s62
    s_mul_i32 s63, s62, 0x5556
    s_lshr_b32 s63, s63, 16
    s_mul_i32 s63, s63, 44032
    s_add_u32 s63, s63, s57
    s_add_u32 s63, s63, 880640
    s_lshl_b32 s62, s62, 10
    s_add_u32 m0, s62, 32768
    s_nop 0
    buffer_load_dwordx4 v6, s[40:43], s63 offen lds
    s_add_u32 s62, s52, 0
    s_mul_i32 s63, s62, 0x5556
    s_lshr_b32 s63, s63, 16
    s_mul_i32 s63, s63, 44032
    s_add_u32 s63, s63, s57
    s_add_u32 s63, s63, 880640
    s_lshl_b32 s62, s62, 10
    s_add_u32 m0, s62, 49152
    s_nop 0
    buffer_load_dwordx4 v6, s[44:47], s63 offen lds
    s_add_u32 s62, s52, 4
    s_mul_i32 s63, s62, 0x5556
    s_lshr_b32 s63, s63, 16
    s_mul_i32 s63, s63, 44032
    s_add_u32 s63, s63, s57
    s_add_u32 s63, s63, 880640
    s_lshl_b32 s62, s62, 10
    s_add_u32 m0, s62, 49152
    s_nop 0
    buffer_load_dwordx4 v10, s[44:47], s63 offen lds
    s_add_u32 s62, s52, 8
    s_mul_i32 s63, s62, 0x5556
    s_lshr_b32 s63, s63, 16
    s_mul_i32 s63, s63, 44032
    s_add_u32 s63, s63, s57
    s_add_u32 s63, s63, 880640
    s_lshl_b32 s62, s62, 10
    s_add_u32 m0, s62, 49152
    s_nop 0
    buffer_load_dwordx4 v18, s[44:47], s63 offen lds
    s_add_u32 s62, s52, 12
    s_sub_u32 s63, s62, 3
    s_cmp_ge_u32 s62, 15
    s_cselect_b32 s62, s63, s62
    s_mul_i32 s63, s62, 0x5556
    s_lshr_b32 s63, s63, 16
    s_mul_i32 s63, s63, 44032
    s_add_u32 s63, s63, s57
    s_add_u32 s63, s63, 880640
    s_lshl_b32 s62, s62, 10
    s_add_u32 m0, s62, 49152
    s_nop 0
    buffer_load_dwordx4 v6, s[44:47], s63 offen lds
    s_cmp_lt_u32 s52, 2
    s_mov_b32 s69, 98304
    s_cselect_b32 s69, s69, 114688
    v_lshrrev_b32 v35, 2, v0
    v_mul_u32_u24 v29, 192, v35
    v_and_b32 v35, 3, v0
    v_lshl_add_u32 v29, v35, 3, v29
    s_add_u32 s69, s69, s65
    v_add_u32 v29, s69, v29
    ds_read_b64_tr_b16 v[36:37], v29 offset:0
    ds_read_b64_tr_b16 v[38:39], v29 offset:64
    ds_read_b64_tr_b16 v[40:41], v29 offset:128
    ds_read_b64_tr_b16 v[42:43], v29 offset:3072
    ds_read_b64_tr_b16 v[44:45], v29 offset:3136
    ds_read_b64_tr_b16 v[46:47], v29 offset:3200
    ds_read_b64_tr_b16 v[48:49], v29 offset:6144
    ds_read_b64_tr_b16 v[50:51], v29 offset:6208
    s_waitcnt lgkmcnt(7)
    v_mfma_f32_16x16x16_bf16 v[52:55], v[12:13], v[36:37], v[52:55]
    ds_read_b64_tr_b16 v[36:37], v29 offset:6272
    s_waitcnt lgkmcnt(7)
    v_mfma_f32_16x16x16_bf16 v[56:59], v[12:13], v[38:39], v[56:59]
    ds_read_b64_tr_b16 v[38:39], v29 offset:9216
    s_waitcnt lgkmcnt(7)
    v_mfma_f32_16x16x16_bf16 v[60:63], v[12:13], v[40:41], v[60:63]
    ds_read_b64_tr_b16 v[40:41], v29 offset:9280
    s_waitcnt lgkmcnt(7)
    v_mfma_f32_16x16x16_bf16 v[52:55], v[12:13], v[42:43], v[52:55]
    ds_read_b64_tr_b16 v[42:43], v29 offset:9344
    s_waitcnt lgkmcnt(7)
    v_mfma_f32_16x16x16_bf16 v[56:59], v[12:13], v[44:45], v[56:59]
    ds_read_b64_tr_b16 v[44:45], v29 offset:12288
    s_waitcnt lgkmcnt(7)
    v_mfma_f32_16x16x16_bf16 v[60:63], v[12:13], v[46:47], v[60:63]
    ds_read_b64_tr_b16 v[46:47], v29 offset:12352
    s_waitcnt lgkmcnt(7)
    v_mfma_f32_16x16x16_bf16 v[52:55], v[12:13], v[48:49], v[52:55]
    ds_read_b64_tr_b16 v[48:49], v29 offset:12416
    s_waitcnt lgkmcnt(7)
    v_mfma_f32_16x16x16_bf16 v[56:59], v[12:13], v[50:51], v[56:59]
    s_waitcnt lgkmcnt(6)
    v_mfma_f32_16x16x16_bf16 v[60:63], v[12:13], v[36:37], v[60:63]
    s_waitcnt lgkmcnt(5)
    v_mfma_f32_16x16x16_bf16 v[52:55], v[12:13], v[38:39], v[52:55]
    s_waitcnt lgkmcnt(4)
    v_mfma_f32_16x16x16_bf16 v[56:59], v[12:13], v[40:41], v[56:59]
    s_waitcnt lgkmcnt(3)
    v_mfma_f32_16x16x16_bf16 v[60:63], v[12:13], v[42:43], v[60:63]
    s_waitcnt lgkmcnt(2)
    v_mfma_f32_16x16x16_bf16 v[52:55], v[12:13], v[44:45], v[52:55]
    s_waitcnt lgkmcnt(1)
    v_mfma_f32_16x16x16_bf16 v[56:59], v[12:13], v[46:47], v[56:59]
    s_waitcnt lgkmcnt(0)
    v_mfma_f32_16x16x16_bf16 v[60:63], v[12:13], v[48:49], v[60:63]
    s_waitcnt vmcnt(12)
    s_add_u32 s62, s52, 0
    s_lshl_b32 s62, s62, 10
    s_add_u32 s62, s62, 0
    v_add_u32 v2, s62, v1
    ds_write_b128 v2, v[192:195]
    s_add_u32 s62, s52, 4
    s_lshl_b32 s62, s62, 10
    s_add_u32 s62, s62, 0
    v_add_u32 v2, s62, v1
    ds_write_b128 v2, v[196:199]
    s_add_u32 s62, s52, 8
    s_lshl_b32 s62, s62, 10
    s_add_u32 s62, s62, 0
    v_add_u32 v2, s62, v1
    ds_write_b128 v2, v[200:203]
    s_add_u32 s62, s52, 12
    s_sub_u32 s63, s62, 3
    s_cmp_ge_u32 s62, 15
    s_cselect_b32 s62, s63, s62
    s_lshl_b32 s62, s62, 10
    s_add_u32 s62, s62, 0
    v_add_u32 v2, s62, v1
    ds_write_b128 v2, v[204:207]
    s_waitcnt vmcnt(8)
    s_add_u32 s62, s52, 0
    s_lshl_b32 s62, s62, 10
    s_add_u32 s62, s62, 16384
    v_add_u32 v2, s62, v1
    ds_write_b128 v2, v[208:211]
    s_add_u32 s62, s52, 4
    s_lshl_b32 s62, s62, 10
    s_add_u32 s62, s62, 16384
    v_add_u32 v2, s62, v1
    ds_write_b128 v2, v[212:215]
    s_add_u32 s62, s52, 8
    s_lshl_b32 s62, s62, 10
    s_add_u32 s62, s62, 16384
    v_add_u32 v2, s62, v1
    ds_write_b128 v2, v[216:219]
    s_add_u32 s62, s52, 12
    s_sub_u32 s63, s62, 3
    s_cmp_ge_u32 s62, 15
    s_cselect_b32 s62, s63, s62
    s_lshl_b32 s62, s62, 10
    s_add_u32 s62, s62, 16384
    v_add_u32 v2, s62, v1
    ds_write_b128 v2, v[220:223]
    s_waitcnt lgkmcnt(0)
    s_barrier
    s_add_u32 s62, s52, 0
    s_mul_i32 s63, s62, 0x5556
    s_lshr_b32 s63, s63, 16
    s_mul_i32 s63, s63, 44032
    s_add_u32 s63, s63, s57
    s_add_u32 s63, s63, 1100800
    s_lshl_b32 s62, s62, 10
    s_add_u32 m0, s62, 65536
    s_nop 0
    buffer_load_dwordx4 v6, s[40:43], s63 offen lds
    s_add_u32 s62, s52, 4
    s_mul_i32 s63, s62, 0x5556
    s_lshr_b32 s63, s63, 16
    s_mul_i32 s63, s63, 44032
    s_add_u32 s63, s63, s57
    s_add_u32 s63, s63, 1100800
    s_lshl_b32 s62, s62, 10
    s_add_u32 m0, s62, 65536
    s_nop 0
    buffer_load_dwordx4 v10, s[40:43], s63 offen lds
    s_add_u32 s62, s52, 8
    s_mul_i32 s63, s62, 0x5556
    s_lshr_b32 s63, s63, 16
    s_mul_i32 s63, s63, 44032
    s_add_u32 s63, s63, s57
    s_add_u32 s63, s63, 1100800
    s_lshl_b32 s62, s62, 10
    s_add_u32 m0, s62, 65536
    s_nop 0
    buffer_load_dwordx4 v18, s[40:43], s63 offen lds
    s_add_u32 s62, s52, 12
    s_sub_u32 s63, s62, 3
    s_cmp_ge_u32 s62, 15
    s_cselect_b32 s62, s63, s62
    s_mul_i32 s63, s62, 0x5556
    s_lshr_b32 s63, s63, 16
    s_mul_i32 s63, s63, 44032
    s_add_u32 s63, s63, s57
    s_add_u32 s63, s63, 1100800
    s_lshl_b32 s62, s62, 10
    s_add_u32 m0, s62, 65536
    s_nop 0
    buffer_load_dwordx4 v6, s[40:43], s63 offen lds
    s_add_u32 s62, s52, 0
    s_mul_i32 s63, s62, 0x5556
    s_lshr_b32 s63, s63, 16
    s_mul_i32 s63, s63, 44032
    s_add_u32 s63, s63, s57
    s_add_u32 s63, s63, 1100800
    s_lshl_b32 s62, s62, 10
    s_add_u32 m0, s62, 81920
    s_nop 0
    buffer_load_dwordx4 v6, s[44:47], s63 offen lds
    s_add_u32 s62, s52, 4
    s_mul_i32 s63, s62, 0x5556
    s_lshr_b32 s63, s63, 16
    s_mul_i32 s63, s63, 44032
    s_add_u32 s63, s63, s57
    s_add_u32 s63, s63, 1100800
    s_lshl_b32 s62, s62, 10
    s_add_u32 m0, s62, 81920
    s_nop 0
    buffer_load_dwordx4 v10, s[44:47], s63 offen lds
    s_add_u32 s62, s52, 8
    s_mul_i32 s63, s62, 0x5556
    s_lshr_b32 s63, s63, 16
    s_mul_i32 s63, s63, 44032
    s_add_u32 s63, s63, s57
    s_add_u32 s63, s63, 1100800
    s_lshl_b32 s62, s62, 10
    s_add_u32 m0, s62, 81920
    s_nop 0
    buffer_load_dwordx4 v18, s[44:47], s63 offen lds
    s_add_u32 s62, s52, 12
    s_sub_u32 s63, s62, 3
    s_cmp_ge_u32 s62, 15
    s_cselect_b32 s62, s63, s62
    s_mul_i32 s63, s62, 0x5556
    s_lshr_b32 s63, s63, 16
    s_mul_i32 s63, s63, 44032
    s_add_u32 s63, s63, s57
    s_add_u32 s63, s63, 1100800
    s_lshl_b32 s62, s62, 10
    s_add_u32 m0, s62, 81920
    s_nop 0
    buffer_load_dwordx4 v6, s[44:47], s63 offen lds
    s_cmp_lt_u32 s52, 2
    s_mov_b32 s69, 0
    s_cselect_b32 s69, s69, 16384
    v_lshrrev_b32 v35, 2, v0
    v_mul_u32_u24 v29, 192, v35
    v_and_b32 v35, 3, v0
    v_lshl_add_u32 v29, v35, 3, v29
    s_add_u32 s69, s69, s65
    v_add_u32 v29, s69, v29
    ds_read_b64_tr_b16 v[36:37], v29 offset:0
    ds_read_b64_tr_b16 v[38:39], v29 offset:64
    ds_read_b64_tr_b16 v[40:41], v29 offset:128
    ds_read_b64_tr_b16 v[42:43], v29 offset:3072
    ds_read_b64_tr_b16 v[44:45], v29 offset:3136
    ds_read_b64_tr_b16 v[46:47], v29 offset:3200
    ds_read_b64_tr_b16 v[48:49], v29 offset:6144
    ds_read_b64_tr_b16 v[50:51], v29 offset:6208
    s_waitcnt lgkmcnt(7)
    v_mfma_f32_16x16x16_bf16 v[52:55], v[12:13], v[36:37], v[52:55]
    ds_read_b64_tr_b16 v[36:37], v29 offset:6272
    s_waitcnt lgkmcnt(7)
    v_mfma_f32_16x16x16_bf16 v[56:59], v[12:13], v[38:39], v[56:59]
    ds_read_b64_tr_b16 v[38:39], v29 offset:9216
    s_waitcnt lgkmcnt(7)
    v_mfma_f32_16x16x16_bf16 v[60:63], v[12:13], v[40:41], v[60:63]
    ds_read_b64_tr_b16 v[40:41], v29 offset:9280
    s_waitcnt lgkmcnt(7)
    v_mfma_f32_16x16x16_bf16 v[52:55], v[12:13], v[42:43], v[52:55]
    ds_read_b64_tr_b16 v[42:43], v29 offset:9344
    s_waitcnt lgkmcnt(7)
    v_mfma_f32_16x16x16_bf16 v[56:59], v[12:13], v[44:45], v[56:59]
    ds_read_b64_tr_b16 v[44:45], v29 offset:12288
    s_waitcnt lgkmcnt(7)
    v_mfma_f32_16x16x16_bf16 v[60:63], v[12:13], v[46:47], v[60:63]
    ds_read_b64_tr_b16 v[46:47], v29 offset:12352
    s_waitcnt lgkmcnt(7)
    v_mfma_f32_16x16x16_bf16 v[52:55], v[12:13], v[48:49], v[52:55]
    ds_read_b64_tr_b16 v[48:49], v29 offset:12416
    s_waitcnt lgkmcnt(7)
    v_mfma_f32_16x16x16_bf16 v[56:59], v[12:13], v[50:51], v[56:59]
    s_waitcnt lgkmcnt(6)
    v_mfma_f32_16x16x16_bf16 v[60:63], v[12:13], v[36:37], v[60:63]
    s_waitcnt lgkmcnt(5)
    v_mfma_f32_16x16x16_bf16 v[52:55], v[12:13], v[38:39], v[52:55]
    s_waitcnt lgkmcnt(4)
    v_mfma_f32_16x16x16_bf16 v[56:59], v[12:13], v[40:41], v[56:59]
    s_waitcnt lgkmcnt(3)
    v_mfma_f32_16x16x16_bf16 v[60:63], v[12:13], v[42:43], v[60:63]
    s_waitcnt lgkmcnt(2)
    v_mfma_f32_16x16x16_bf16 v[52:55], v[12:13], v[44:45], v[52:55]
    s_waitcnt lgkmcnt(1)
    v_mfma_f32_16x16x16_bf16 v[56:59], v[12:13], v[46:47], v[56:59]
    s_waitcnt lgkmcnt(0)
    v_mfma_f32_16x16x16_bf16 v[60:63], v[12:13], v[48:49], v[60:63]
    s_waitcnt vmcnt(8)
    s_barrier
    s_add_u32 s62, s52, 0
    s_mul_i32 s63, s62, 0x5556
    s_lshr_b32 s63, s63, 16
    s_mul_i32 s63, s63, 44032
    s_add_u32 s63, s63, s57
    s_add_u32 s63, s63, 1320960
    s_lshl_b32 s62, s62, 10
    s_add_u32 m0, s62, 98304
    s_nop 0
    buffer_load_dwordx4 v6, s[40:43], s63 offen lds
    s_add_u32 s62, s52, 4
    s_sub_u32 s63, s62, 3
    s_cmp_ge_u32 s62, 6
    s_cselect_b32 s62, s63, s62
    s_mul_i32 s63, s62, 0x5556
    s_lshr_b32 s63, s63, 16
    s_mul_i32 s63, s63, 44032
    s_add_u32 s63, s63, s57
    s_add_u32 s63, s63, 1320960
    s_lshl_b32 s62, s62, 10
    s_add_u32 m0, s62, 98304
    s_nop 0
    buffer_load_dwordx4 v10, s[40:43], s63 offen lds
    s_add_u32 s62, s52, 0
    s_mul_i32 s63, s62, 0x5556
    s_lshr_b32 s63, s63, 16
    s_mul_i32 s63, s63, 44032
    s_add_u32 s63, s63, s57
    s_add_u32 s63, s63, 1320960
    s_lshl_b32 s62, s62, 10
    s_add_u32 m0, s62, 114688
    s_nop 0
    buffer_load_dwordx4 v6, s[44:47], s63 offen lds
    s_add_u32 s62, s52, 4
    s_sub_u32 s63, s62, 3
    s_cmp_ge_u32 s62, 6
    s_cselect_b32 s62, s63, s62
    s_mul_i32 s63, s62, 0x5556
    s_lshr_b32 s63, s63, 16
    s_mul_i32 s63, s63, 44032
    s_add_u32 s63, s63, s57
    s_add_u32 s63, s63, 1320960
    s_lshl_b32 s62, s62, 10
    s_add_u32 m0, s62, 114688
    s_nop 0
    buffer_load_dwordx4 v10, s[44:47], s63 offen lds
    s_cmp_lt_u32 s52, 2
    s_mov_b32 s69, 32768
    s_cselect_b32 s69, s69, 49152
    v_lshrrev_b32 v35, 2, v0
    v_mul_u32_u24 v29, 192, v35
    v_and_b32 v35, 3, v0
    v_lshl_add_u32 v29, v35, 3, v29
    s_add_u32 s69, s69, s65
    v_add_u32 v29, s69, v29
    ds_read_b64_tr_b16 v[36:37], v29 offset:0
    ds_read_b64_tr_b16 v[38:39], v29 offset:64
    ds_read_b64_tr_b16 v[40:41], v29 offset:128
    ds_read_b64_tr_b16 v[42:43], v29 offset:3072
    ds_read_b64_tr_b16 v[44:45], v29 offset:3136
    ds_read_b64_tr_b16 v[46:47], v29 offset:3200
    ds_read_b64_tr_b16 v[48:49], v29 offset:6144
    ds_read_b64_tr_b16 v[50:51], v29 offset:6208
    s_waitcnt lgkmcnt(7)
    v_mfma_f32_16x16x16_bf16 v[52:55], v[12:13], v[36:37], v[52:55]
    ds_read_b64_tr_b16 v[36:37], v29 offset:6272
    s_waitcnt lgkmcnt(7)
    v_mfma_f32_16x16x16_bf16 v[56:59], v[12:13], v[38:39], v[56:59]
    ds_read_b64_tr_b16 v[38:39], v29 offset:9216
    s_waitcnt lgkmcnt(7)
    v_mfma_f32_16x16x16_bf16 v[60:63], v[12:13], v[40:41], v[60:63]
    ds_read_b64_tr_b16 v[40:41], v29 offset:9280
    s_waitcnt lgkmcnt(7)
    v_mfma_f32_16x16x16_bf16 v[52:55], v[12:13], v[42:43], v[52:55]
    ds_read_b64_tr_b16 v[42:43], v29 offset:9344
    s_waitcnt lgkmcnt(7)
    v_mfma_f32_16x16x16_bf16 v[56:59], v[12:13], v[44:45], v[56:59]
    ds_read_b64_tr_b16 v[44:45], v29 offset:12288
    s_waitcnt lgkmcnt(7)
    v_mfma_f32_16x16x16_bf16 v[60:63], v[12:13], v[46:47], v[60:63]
    ds_read_b64_tr_b16 v[46:47], v29 offset:12352
    s_waitcnt lgkmcnt(7)
    v_mfma_f32_16x16x16_bf16 v[52:55], v[12:13], v[48:49], v[52:55]
    ds_read_b64_tr_b16 v[48:49], v29 offset:12416
    s_waitcnt lgkmcnt(7)
    v_mfma_f32_16x16x16_bf16 v[56:59], v[12:13], v[50:51], v[56:59]
    s_waitcnt lgkmcnt(6)
    v_mfma_f32_16x16x16_bf16 v[60:63], v[12:13], v[36:37], v[60:63]
    s_waitcnt lgkmcnt(5)
    v_mfma_f32_16x16x16_bf16 v[52:55], v[12:13], v[38:39], v[52:55]
    s_waitcnt lgkmcnt(4)
    v_mfma_f32_16x16x16_bf16 v[56:59], v[12:13], v[40:41], v[56:59]
    s_waitcnt lgkmcnt(3)
    v_mfma_f32_16x16x16_bf16 v[60:63], v[12:13], v[42:43], v[60:63]
    s_waitcnt lgkmcnt(2)
    v_mfma_f32_16x16x16_bf16 v[52:55], v[12:13], v[44:45], v[52:55]
    s_waitcnt lgkmcnt(1)
    v_mfma_f32_16x16x16_bf16 v[56:59], v[12:13], v[46:47], v[56:59]
    s_waitcnt lgkmcnt(0)
    v_mfma_f32_16x16x16_bf16 v[60:63], v[12:13], v[48:49], v[60:63]
    s_waitcnt vmcnt(4)
    s_barrier
    s_add_u32 s62, s56, s59
    s_add_u32 s62, s62, 0
    s_add_u32 m0, s61, 0
    s_nop 0
    buffer_load_dwordx4 v5, s[48:51], s62 offen lds
    s_add_u32 s62, s62, 8192
    s_add_u32 m0, m0, 1024
    s_nop 0
    buffer_load_dwordx4 v5, s[48:51], s62 offen lds
    s_add_u32 s62, s62, 8192
    s_add_u32 m0, m0, 1024
    s_nop 0
    buffer_load_dwordx4 v5, s[48:51], s62 offen lds
    s_add_u32 s62, s62, 8192
    s_add_u32 m0, m0, 1024
    s_nop 0
    buffer_load_dwordx4 v5, s[48:51], s62 offen lds
    s_add_u32 s62, s56, s59
    s_add_u32 s62, s62, 704512
    s_add_u32 m0, s61, 16384
    s_nop 0
    buffer_load_dwordx4 v5, s[48:51], s62 offen lds
    s_add_u32 s62, s62, 8192
    s_add_u32 m0, m0, 1024
    s_nop 0
    buffer_load_dwordx4 v5, s[48:51], s62 offen lds
    s_add_u32 s62, s62, 8192
    s_add_u32 m0, m0, 1024
    s_nop 0
    buffer_load_dwordx4 v5, s[48:51], s62 offen lds
    s_add_u32 s62, s62, 8192
    s_add_u32 m0, m0, 1024
    s_nop 0
    buffer_load_dwordx4 v5, s[48:51], s62 offen lds
    s_add_u32 s62, s56, s59
    s_add_u32 s62, s62, 524288
    buffer_load_dwordx4 v[224:227], v5, s[48:51], s62 offen
    s_add_u32 s62, s62, 8192
    buffer_load_dwordx4 v[228:231], v5, s[48:51], s62 offen
    s_add_u32 s62, s62, 8192
    buffer_load_dwordx4 v[232:235], v5, s[48:51], s62 offen
    s_add_u32 s62, s62, 8192
    buffer_load_dwordx4 v[236:239], v5, s[48:51], s62 offen
    s_add_u32 s62, s56, s59
    s_add_u32 s62, s62, 1228800
    buffer_load_dwordx4 v[240:243], v5, s[48:51], s62 offen
    s_add_u32 s62, s62, 8192
    buffer_load_dwordx4 v[244:247], v5, s[48:51], s62 offen
    s_add_u32 s62, s62, 8192
    buffer_load_dwordx4 v[248:251], v5, s[48:51], s62 offen
    s_add_u32 s62, s62, 8192
    buffer_load_dwordx4 v[252:255], v5, s[48:51], s62 offen
    s_cmp_lt_u32 s52, 2
    s_mov_b32 s69, 65536
    s_cselect_b32 s69, s69, 81920
    v_lshrrev_b32 v35, 2, v0
    v_mul_u32_u24 v29, 192, v35
    v_and_b32 v35, 3, v0
    v_lshl_add_u32 v29, v35, 3, v29
    s_add_u32 s69, s69, s65
    v_add_u32 v29, s69, v29
    ds_read_b64_tr_b16 v[36:37], v29 offset:0
    ds_read_b64_tr_b16 v[38:39], v29 offset:64
    ds_read_b64_tr_b16 v[40:41], v29 offset:128
    ds_read_b64_tr_b16 v[42:43], v29 offset:3072
    ds_read_b64_tr_b16 v[44:45], v29 offset:3136
    ds_read_b64_tr_b16 v[46:47], v29 offset:3200
    ds_read_b64_tr_b16 v[48:49], v29 offset:6144
    ds_read_b64_tr_b16 v[50:51], v29 offset:6208
    s_waitcnt lgkmcnt(7)
    v_mfma_f32_16x16x16_bf16 v[52:55], v[12:13], v[36:37], v[52:55]
    ds_read_b64_tr_b16 v[36:37], v29 offset:6272
    s_waitcnt lgkmcnt(7)
    v_mfma_f32_16x16x16_bf16 v[56:59], v[12:13], v[38:39], v[56:59]
    ds_read_b64_tr_b16 v[38:39], v29 offset:9216
    s_waitcnt lgkmcnt(7)
    v_mfma_f32_16x16x16_bf16 v[60:63], v[12:13], v[40:41], v[60:63]
    ds_read_b64_tr_b16 v[40:41], v29 offset:9280
    s_waitcnt lgkmcnt(7)
    v_mfma_f32_16x16x16_bf16 v[52:55], v[12:13], v[42:43], v[52:55]
    ds_read_b64_tr_b16 v[42:43], v29 offset:9344
    s_waitcnt lgkmcnt(7)
    v_mfma_f32_16x16x16_bf16 v[56:59], v[12:13], v[44:45], v[56:59]
    ds_read_b64_tr_b16 v[44:45], v29 offset:12288
    s_waitcnt lgkmcnt(7)
    v_mfma_f32_16x16x16_bf16 v[60:63], v[12:13], v[46:47], v[60:63]
    ds_read_b64_tr_b16 v[46:47], v29 offset:12352
    s_waitcnt lgkmcnt(7)
    v_mfma_f32_16x16x16_bf16 v[52:55], v[12:13], v[48:49], v[52:55]
    ds_read_b64_tr_b16 v[48:49], v29 offset:12416
    s_waitcnt lgkmcnt(7)
    v_mfma_f32_16x16x16_bf16 v[56:59], v[12:13], v[50:51], v[56:59]
    s_waitcnt lgkmcnt(6)
    v_mfma_f32_16x16x16_bf16 v[60:63], v[12:13], v[36:37], v[60:63]
    s_waitcnt lgkmcnt(5)
    v_mfma_f32_16x16x16_bf16 v[52:55], v[12:13], v[38:39], v[52:55]
    s_waitcnt lgkmcnt(4)
    v_mfma_f32_16x16x16_bf16 v[56:59], v[12:13], v[40:41], v[56:59]
    s_waitcnt lgkmcnt(3)
    v_mfma_f32_16x16x16_bf16 v[60:63], v[12:13], v[42:43], v[60:63]
    s_waitcnt lgkmcnt(2)
    v_mfma_f32_16x16x16_bf16 v[52:55], v[12:13], v[44:45], v[52:55]
    s_waitcnt lgkmcnt(1)
    v_mfma_f32_16x16x16_bf16 v[56:59], v[12:13], v[46:47], v[56:59]
    s_waitcnt lgkmcnt(0)
    v_mfma_f32_16x16x16_bf16 v[60:63], v[12:13], v[48:49], v[60:63]
    s_waitcnt vmcnt(16)
    s_barrier
    s_mul_i32 s62, s52, 88064
    s_lshl_b32 s63, s57, 5
    s_add_u32 s62, s62, s63
    s_add_u32 s62, s62, 983040
    buffer_load_dword v8, v1, s[28:31], s62 offen offset:0
    buffer_load_dword v8, v1, s[28:31], s62 offen offset:1024
    buffer_load_dword v8, v1, s[28:31], s62 offen offset:2048
    buffer_load_dword v8, v1, s[28:31], s62 offen offset:3072
    s_add_u32 s62, s62, 4096
    buffer_load_dword v8, v1, s[28:31], s62 offen offset:0
    buffer_load_dword v8, v1, s[28:31], s62 offen offset:1024
    s_add_u32 s62, s56, s59
    s_add_u32 s62, s62, 131072
    s_add_u32 m0, s61, 32768
    s_nop 0
    buffer_load_dwordx4 v5, s[48:51], s62 offen lds
    s_add_u32 s62, s62, 8192
    s_add_u32 m0, m0, 1024
    s_nop 0
    buffer_load_dwordx4 v5, s[48:51], s62 offen lds
    s_add_u32 s62, s62, 8192
    s_add_u32 m0, m0, 1024
    s_nop 0
    buffer_load_dwordx4 v5, s[48:51], s62 offen lds
    s_add_u32 s62, s62, 8192
    s_add_u32 m0, m0, 1024
    s_nop 0
    buffer_load_dwordx4 v5, s[48:51], s62 offen lds
    s_add_u32 s62, s56, s59
    s_add_u32 s62, s62, 835584
    s_add_u32 m0, s61, 49152
    s_nop 0
    buffer_load_dwordx4 v5, s[48:51], s62 offen lds
    s_add_u32 s62, s62, 8192
    s_add_u32 m0, m0, 1024
    s_nop 0
    buffer_load_dwordx4 v5, s[48:51], s62 offen lds
    s_add_u32 s62, s62, 8192
    s_add_u32 m0, m0, 1024
    s_nop 0
    buffer_load_dwordx4 v5, s[48:51], s62 offen lds
    s_add_u32 s62, s62, 8192
    s_add_u32 m0, m0, 1024
    s_nop 0
    buffer_load_dwordx4 v5, s[48:51], s62 offen lds
    s_lshr_b32 s62, s2, 3
    s_lshl_b32 s62, s62, 2
    s_add_u32 s62, s62, s52
    s_mul_i32 s62, s62, 4096
    s_add_u32 s62, s62, 0
    buffer_load_dword v8, v1, s[36:39], s62 offen offset:0
    buffer_load_dword v8, v1, s[36:39], s62 offen offset:1024
    buffer_load_dword v8, v1, s[36:39], s62 offen offset:2048
    buffer_load_dword v8, v1, s[36:39], s62 offen offset:3072
    s_cmp_lt_u32 s52, 2
    s_mov_b32 s69, 98304
    s_cselect_b32 s69, s69, 114688
    v_lshrrev_b32 v35, 2, v0
    v_mul_u32_u24 v29, 192, v35
    v_and_b32 v35, 3, v0
    v_lshl_add_u32 v29, v35, 3, v29
    s_add_u32 s69, s69, s65
    v_add_u32 v29, s69, v29
    ds_read_b64_tr_b16 v[36:37], v29 offset:0
    ds_read_b64_tr_b16 v[38:39], v29 offset:64
    ds_read_b64_tr_b16 v[40:41], v29 offset:128
    ds_read_b64_tr_b16 v[42:43], v29 offset:3072
    ds_read_b64_tr_b16 v[44:45], v29 offset:3136
    ds_read_b64_tr_b16 v[46:47], v29 offset:3200
    s_waitcnt lgkmcnt(5)
    v_mfma_f32_16x16x16_bf16 v[52:55], v[12:13], v[36:37], v[52:55]
    s_waitcnt lgkmcnt(4)
    v_mfma_f32_16x16x16_bf16 v[56:59], v[12:13], v[38:39], v[56:59]
    s_waitcnt lgkmcnt(3)
    v_mfma_f32_16x16x16_bf16 v[60:63], v[12:13], v[40:41], v[60:63]
    s_waitcnt lgkmcnt(2)
    v_mfma_f32_16x16x16_bf16 v[52:55], v[12:13], v[42:43], v[52:55]
    s_waitcnt lgkmcnt(1)
    v_mfma_f32_16x16x16_bf16 v[56:59], v[12:13], v[44:45], v[56:59]
    s_waitcnt lgkmcnt(0)
    v_mfma_f32_16x16x16_bf16 v[60:63], v[12:13], v[46:47], v[60:63]
    s_lshr_b32 s70, s52, 1
    s_add_u32 s70, s70, 3
    s_lshl_b32 s70, s70, 9
    s_lshl_b32 s71, s64, 7
    s_add_u32 s70, s70, s71
    s_add_u32 s70, s70, 158720
    v_cvt_pk_bf16_f32 v30, v52, v52
    v_lshlrev_b32 v30, 16, v30
    v_sub_f32 v31, v52, v30
    v_cvt_pk_bf16_f32 v32, v52, v31
    v_and_b32 v30, 0xffff0000, v32
    v_sub_f32 v31, v31, v30
    v_cvt_pk_bf16_f32 v33, v31, 0
    v_and_b32 v30, 15, v0
    v_lshlrev_b32 v30, 3, v30
    v_add_u32 v30, s70, v30
    s_mov_b64 exec, 0xffff
    ds_write_b64 v30, v[32:33]
    s_mov_b64 exec, -1
    v_mov_b32 v32, 0
    v_mov_b32 v33, 0
    v_add_u32 v30, 256, v30
    s_mov_b64 exec, 0xffff
    ds_write_b64 v30, v[32:33]
    s_mov_b64 exec, -1
    s_waitcnt lgkmcnt(0)
    s_lshr_b32 s70, s52, 1
    s_add_u32 s70, s70, 5
    s_lshl_b32 s70, s70, 9
    s_lshl_b32 s71, s64, 7
    s_add_u32 s70, s70, s71
    s_add_u32 s70, s70, 158720
    v_cvt_pk_bf16_f32 v30, v56, v56
    v_lshlrev_b32 v30, 16, v30
    v_sub_f32 v31, v56, v30
    v_cvt_pk_bf16_f32 v32, v56, v31
    v_and_b32 v30, 0xffff0000, v32
    v_sub_f32 v31, v31, v30
    v_cvt_pk_bf16_f32 v33, v31, 0
    v_and_b32 v30, 15, v0
    v_lshlrev_b32 v30, 3, v30
    v_add_u32 v30, s70, v30
    s_mov_b64 exec, 0xffff
    ds_write_b64 v30, v[32:33]
    s_mov_b64 exec, -1
    v_mov_b32 v32, 0
    v_mov_b32 v33, 0
    v_add_u32 v30, 256, v30
    s_mov_b64 exec, 0xffff
    ds_write_b64 v30, v[32:33]
    s_mov_b64 exec, -1
    s_waitcnt lgkmcnt(0)
    s_lshr_b32 s70, s52, 1
    s_add_u32 s70, s70, 7
    s_lshl_b32 s70, s70, 9
    s_lshl_b32 s71, s64, 7
    s_add_u32 s70, s70, s71
    s_add_u32 s70, s70, 158720
    v_cvt_pk_bf16_f32 v30, v60, v60
    v_lshlrev_b32 v30, 16, v30
    v_sub_f32 v31, v60, v30
    v_cvt_pk_bf16_f32 v32, v60, v31
    v_and_b32 v30, 0xffff0000, v32
    v_sub_f32 v31, v31, v30
    v_cvt_pk_bf16_f32 v33, v31, 0
    v_and_b32 v30, 15, v0
    v_lshlrev_b32 v30, 3, v30
    v_add_u32 v30, s70, v30
    s_mov_b64 exec, 0xffff
    ds_write_b64 v30, v[32:33]
    s_mov_b64 exec, -1
    v_mov_b32 v32, 0
    v_mov_b32 v33, 0
    v_add_u32 v30, 256, v30
    s_mov_b64 exec, 0xffff
    ds_write_b64 v30, v[32:33]
    s_mov_b64 exec, -1
    s_waitcnt lgkmcnt(0)
    s_barrier
    s_add_u32 s62, s56, s59
    s_add_u32 s62, s62, 262144
    s_add_u32 m0, s61, 65536
    s_nop 0
    buffer_load_dwordx4 v5, s[48:51], s62 offen lds
    s_add_u32 s62, s62, 8192
    s_add_u32 m0, m0, 1024
    s_nop 0
    buffer_load_dwordx4 v5, s[48:51], s62 offen lds
    s_add_u32 s62, s62, 8192
    s_add_u32 m0, m0, 1024
    s_nop 0
    buffer_load_dwordx4 v5, s[48:51], s62 offen lds
    s_add_u32 s62, s62, 8192
    s_add_u32 m0, m0, 1024
    s_nop 0
    buffer_load_dwordx4 v5, s[48:51], s62 offen lds
    s_add_u32 s62, s56, s59
    s_add_u32 s62, s62, 966656
    s_add_u32 m0, s61, 81920
    s_nop 0
    buffer_load_dwordx4 v5, s[48:51], s62 offen lds
    s_add_u32 s62, s62, 8192
    s_add_u32 m0, m0, 1024
    s_nop 0
    buffer_load_dwordx4 v5, s[48:51], s62 offen lds
    s_add_u32 s62, s62, 8192
    s_add_u32 m0, m0, 1024
    s_nop 0
    buffer_load_dwordx4 v5, s[48:51], s62 offen lds
    s_add_u32 s62, s62, 8192
    s_add_u32 m0, m0, 1024
    s_nop 0
    buffer_load_dwordx4 v5, s[48:51], s62 offen lds
    s_barrier
    s_add_u32 s62, s56, s59
    s_add_u32 s62, s62, 393216
    s_add_u32 m0, s61, 98304
    s_nop 0
    buffer_load_dwordx4 v5, s[48:51], s62 offen lds
    s_add_u32 s62, s62, 8192
    s_add_u32 m0, m0, 1024
    s_nop 0
    buffer_load_dwordx4 v5, s[48:51], s62 offen lds
    s_add_u32 s62, s62, 8192
    s_add_u32 m0, m0, 1024
    s_nop 0
    buffer_load_dwordx4 v5, s[48:51], s62 offen lds
    s_add_u32 s62, s62, 8192
    s_add_u32 m0, m0, 1024
    s_nop 0
    buffer_load_dwordx4 v5, s[48:51], s62 offen lds
    s_add_u32 s62, s56, s59
    s_add_u32 s62, s62, 1097728
    s_add_u32 m0, s61, 114688
    s_nop 0
    buffer_load_dwordx4 v5, s[48:51], s62 offen lds
    s_add_u32 s62, s62, 8192
    s_add_u32 m0, m0, 1024
    s_nop 0
    buffer_load_dwordx4 v5, s[48:51], s62 offen lds
    s_add_u32 s62, s62, 8192
    s_add_u32 m0, m0, 1024
    s_nop 0
    buffer_load_dwordx4 v5, s[48:51], s62 offen lds
    s_add_u32 s62, s62, 8192
    s_add_u32 m0, m0, 1024
    s_nop 0
    buffer_load_dwordx4 v5, s[48:51], s62 offen lds
    s_waitcnt vmcnt(20)
    s_barrier
    s_waitcnt vmcnt(8)
    s_barrier
    v_add_u32 v2, 0, v3
    ds_write_b128 v2, v[224:227] offset:0
    ds_write_b128 v2, v[228:231] offset:1024
    ds_write_b128 v2, v[232:235] offset:2048
    ds_write_b128 v2, v[236:239] offset:3072
    v_add_u32 v2, 16384, v3
    ds_write_b128 v2, v[240:243] offset:0
    ds_write_b128 v2, v[244:247] offset:1024
    ds_write_b128 v2, v[248:251] offset:2048
    ds_write_b128 v2, v[252:255] offset:3072
    s_waitcnt vmcnt(0)
    s_waitcnt lgkmcnt(0)
    s_barrier
    s_lshr_b32 s63, s52, 1
    s_mul_i32 s63, s63, 704512
    s_and_b32 s62, s52, 1
    s_mul_i32 s62, s62, 24576
    s_add_u32 s62, s62, s63
    s_add_u32 s62, s62, s56
    s_add_u32 s62, s62, 655360
    s_mul_i32 s63, s52, 3072
    s_add_u32 m0, s63, 32768
    s_nop 0
    buffer_load_dwordx4 v5, s[48:51], s62 offen lds
    s_add_u32 s62, s62, 8192
    s_add_u32 m0, m0, 1024
    s_nop 0
    buffer_load_dwordx4 v5, s[48:51], s62 offen lds
    s_add_u32 s62, s62, 8192
    s_add_u32 m0, m0, 1024
    s_nop 0
    buffer_load_dwordx4 v5, s[48:51], s62 offen lds
    v_add_u32 v2, 49152, v3
    ds_write_b128 v2, v[64:67] offset:0
    ds_write_b128 v2, v[68:71] offset:1024
    ds_write_b128 v2, v[72:75] offset:2048
    ds_write_b128 v2, v[76:79] offset:3072
    s_waitcnt lgkmcnt(0)
    s_barrier
    v_add_u32 v2, 65536, v3
    ds_write_b128 v2, v[80:83] offset:0
    ds_write_b128 v2, v[84:87] offset:1024
    ds_write_b128 v2, v[88:91] offset:2048
    ds_write_b128 v2, v[92:95] offset:3072
    v_add_u32 v2, 81920, v3
    ds_write_b128 v2, v[96:99] offset:0
    ds_write_b128 v2, v[100:103] offset:1024
    ds_write_b128 v2, v[104:107] offset:2048
    ds_write_b128 v2, v[108:111] offset:3072
    s_waitcnt vmcnt(0)
    s_waitcnt lgkmcnt(0)
    s_barrier
    v_add_u32 v2, 98304, v3
    ds_write_b128 v2, v[112:115] offset:0
    ds_write_b128 v2, v[116:119] offset:1024
    ds_write_b128 v2, v[120:123] offset:2048
    ds_write_b128 v2, v[124:127] offset:3072
    v_add_u32 v2, 114688, v3
    ds_write_b128 v2, v[128:131] offset:0
    ds_write_b128 v2, v[132:135] offset:1024
    ds_write_b128 v2, v[136:139] offset:2048
    ds_write_b128 v2, v[140:143] offset:3072
    s_waitcnt lgkmcnt(0)
    s_barrier
    v_add_u32 v2, 0, v3
    ds_write_b128 v2, v[144:147] offset:0
    ds_write_b128 v2, v[148:151] offset:1024
    ds_write_b128 v2, v[152:155] offset:2048
    ds_write_b128 v2, v[156:159] offset:3072
    s_add_u32 s62, s56, s59
    s_add_u32 s62, s62, 0
    s_add_u32 m0, s61, 16384
    s_nop 0
    buffer_load_dwordx4 v5, s[36:39], s62 offen lds
    s_add_u32 s62, s62, 8192
    s_add_u32 m0, m0, 1024
    s_nop 0
    buffer_load_dwordx4 v5, s[36:39], s62 offen lds
    s_add_u32 s62, s62, 8192
    s_add_u32 m0, m0, 1024
    s_nop 0
    buffer_load_dwordx4 v5, s[36:39], s62 offen lds
    s_add_u32 s62, s62, 8192
    s_add_u32 m0, m0, 1024
    s_nop 0
    buffer_load_dwordx4 v5, s[36:39], s62 offen lds
    s_waitcnt vmcnt(3)
    s_waitcnt lgkmcnt(0)
    s_barrier
    s_add_u32 s62, s56, s59
    s_add_u32 s62, s62, 131072
    s_add_u32 m0, s61, 32768
    s_nop 0
    buffer_load_dwordx4 v5, s[36:39], s62 offen lds
    s_waitcnt vmcnt(3)
    s_add_u32 s62, s62, 8192
    s_add_u32 m0, m0, 1024
    s_nop 0
    buffer_load_dwordx4 v5, s[36:39], s62 offen lds
    s_waitcnt vmcnt(3)
    s_add_u32 s62, s62, 8192
    s_add_u32 m0, m0, 1024
    s_nop 0
    buffer_load_dwordx4 v5, s[36:39], s62 offen lds
    s_waitcnt vmcnt(3)
    s_add_u32 s62, s62, 8192
    s_add_u32 m0, m0, 1024
    s_nop 0
    buffer_load_dwordx4 v5, s[36:39], s62 offen lds
    s_waitcnt vmcnt(3)
    s_cmp_eq_u32 s21, 0
    s_mov_b32 s76, 98304
    s_cselect_b32 s76, s76, 131072
    s_mov_b32 s77, 69632
    s_cselect_b32 s77, s77, 73728
    s_barrier
    s_cmp_lt_u32 s52, 2
    s_mov_b32 s69, 49152
    s_cselect_b32 s69, s69, 65536
    s_mov_b32 s71, 81920
    s_cselect_b32 s71, s71, 98304
    v_add_u32 v29, s69, v7
    v_add_u32 v35, s71, v7
    s_add_u32 s75, s23, 1
    s_mov_b32 s74, 576
    s_add_u32 s72, s18, s74
    s_addc_u32 s73, s19, 0
    ds_read_b64_tr_b16 v[64:65], v29 offset:0
    ds_read_b64_tr_b16 v[66:67], v29 offset:256
    ds_read_b64_tr_b16 v[68:69], v29 offset:2048
    ds_read_b64_tr_b16 v[70:71], v29 offset:2304
    ds_read_b64_tr_b16 v[72:73], v29 offset:4096
    ds_read_b64_tr_b16 v[74:75], v29 offset:4352
    ds_read_b64_tr_b16 v[76:77], v29 offset:6144
    ds_read_b64_tr_b16 v[78:79], v29 offset:6400
    ds_read_b64_tr_b16 v[80:81], v29 offset:8192
    ds_read_b64_tr_b16 v[82:83], v29 offset:8448
    ds_read_b64_tr_b16 v[84:85], v29 offset:10240
    ds_read_b64_tr_b16 v[86:87], v29 offset:10496
    ds_read_b64_tr_b16 v[88:89], v29 offset:12288
    ds_read_b64_tr_b16 v[90:91], v29 offset:12544
    s_waitcnt lgkmcnt(0)
    ds_read_b64_tr_b16 v[92:93], v29 offset:14336
    ds_read_b64_tr_b16 v[94:95], v29 offset:14592
    s_waitcnt lgkmcnt(0)
    s_barrier
    ds_read_b64_tr_b16 v[96:97], v35 offset:0
    ds_read_b64_tr_b16 v[98:99], v35 offset:256
    ds_read_b64_tr_b16 v[100:101], v35 offset:2048
    ds_read_b64_tr_b16 v[102:103], v35 offset:2304
    ds_read_b64_tr_b16 v[104:105], v35 offset:4096
    ds_read_b64_tr_b16 v[106:107], v35 offset:4352
    ds_read_b64_tr_b16 v[108:109], v35 offset:6144
    ds_read_b64_tr_b16 v[110:111], v35 offset:6400
    ds_read_b64_tr_b16 v[112:113], v35 offset:8192
    ds_read_b64_tr_b16 v[114:115], v35 offset:8448
    ds_read_b64_tr_b16 v[116:117], v35 offset:10240
    ds_read_b64_tr_b16 v[118:119], v35 offset:10496
    ds_read_b64_tr_b16 v[120:121], v35 offset:12288
    ds_read_b64_tr_b16 v[122:123], v35 offset:12544
    s_waitcnt lgkmcnt(0)
    ds_read_b64_tr_b16 v[124:125], v35 offset:14336
    ds_read_b64_tr_b16 v[126:127], v35 offset:14592
    s_waitcnt lgkmcnt(0)
    s_lshl_b32 s79, s22, 2
    s_add_u32 s79, s79, s52
    s_lshl_b32 s79, s79, 9
    s_add_u32 s79, s79, s76
    s_add_u32 s79, s79, 256
    s_add_u32 s82, s18, s79
    s_addc_u32 s83, s19, 0
    s_load_dword s84, s[82:83], 0
    s_load_dword s84, s[82:83], 64
    s_load_dword s84, s[82:83], 128
    s_load_dword s84, s[82:83], 192
    s_lshl_b32 s79, s22, 1
    s_and_b32 s74, s52, 1
    s_add_u32 s79, s79, s74
    s_lshr_b32 s74, s79, 2
    s_lshl_b32 s74, s74, 9
    s_and_b32 s79, s79, 3
    s_lshl_b32 s79, s79, 6
    s_add_u32 s79, s79, s74
    s_add_u32 s79, s79, s77
    s_add_u32 s79, s79, 256
    s_add_u32 s86, s18, s79
    s_addc_u32 s87, s19, 0
    s_load_dword s85, s[86:87], 0
    s_barrier
    s_waitcnt lgkmcnt(0)
    buffer_load_dwordx4 v[128:131], v11, s[28:31], s76 offen offset:0 sc1
    buffer_load_dwordx4 v[132:135], v11, s[28:31], s76 offen offset:2048 sc1
    s_add_u32 s76, s76, 4096
    buffer_load_dwordx4 v[136:139], v11, s[28:31], s76 offen offset:0 sc1
    buffer_load_dwordx4 v[140:143], v11, s[28:31], s76 offen offset:2048 sc1
    s_add_u32 s76, s76, 4096
    buffer_load_dwordx4 v[144:147], v11, s[28:31], s76 offen offset:0 sc1
    buffer_load_dwordx4 v[148:151], v11, s[28:31], s76 offen offset:2048 sc1
    s_add_u32 s76, s76, 4096
    buffer_load_dwordx4 v[152:155], v11, s[28:31], s76 offen offset:0 sc1
    buffer_load_dwordx4 v[156:159], v11, s[28:31], s76 offen offset:2048 sc1
    s_waitcnt vmcnt(7)
    v_mfma_f32_16x16x32_bf16 v[56:59], v[64:67], v[128:131], 0
    s_add_u32 s76, s76, 4096
    buffer_load_dwordx4 v[128:131], v11, s[28:31], s76 offen offset:0 sc1
    s_waitcnt vmcnt(7)
    v_mfma_f32_16x16x32_bf16 v[56:59], v[68:71], v[132:135], v[56:59]
    buffer_load_dwordx4 v[132:135], v11, s[28:31], s76 offen offset:2048 sc1
    s_waitcnt vmcnt(7)
    v_mfma_f32_16x16x32_bf16 v[56:59], v[72:75], v[136:139], v[56:59]
    s_add_u32 s76, s76, 4096
    buffer_load_dwordx4 v[136:139], v11, s[28:31], s76 offen offset:0 sc1
    s_waitcnt vmcnt(7)
    v_mfma_f32_16x16x32_bf16 v[56:59], v[76:79], v[140:143], v[56:59]
    buffer_load_dwordx4 v[140:143], v11, s[28:31], s76 offen offset:2048 sc1
    s_waitcnt vmcnt(7)
    v_mfma_f32_16x16x32_bf16 v[56:59], v[80:83], v[144:147], v[56:59]
    s_add_u32 s76, s76, 4096
    buffer_load_dwordx4 v[144:147], v11, s[28:31], s76 offen offset:0 sc1
    s_waitcnt vmcnt(7)
    v_mfma_f32_16x16x32_bf16 v[56:59], v[84:87], v[148:151], v[56:59]
    buffer_load_dwordx4 v[148:151], v11, s[28:31], s76 offen offset:2048 sc1
    s_waitcnt vmcnt(7)
    v_mfma_f32_16x16x32_bf16 v[56:59], v[88:91], v[152:155], v[56:59]
    s_add_u32 s76, s76, 4096
    buffer_load_dwordx4 v[152:155], v11, s[28:31], s76 offen offset:0 sc1
    s_waitcnt vmcnt(7)
    v_mfma_f32_16x16x32_bf16 v[56:59], v[92:95], v[156:159], v[56:59]
    buffer_load_dwordx4 v[156:159], v11, s[28:31], s76 offen offset:2048 sc1
    buffer_load_dwordx4 v[64:67], v16, s[28:31], s77 offen offset:0 sc1
    buffer_load_dwordx4 v[68:71], v16, s[28:31], s77 offen offset:512 sc1
    buffer_load_dwordx4 v[72:75], v16, s[28:31], s77 offen offset:1024 sc1
    buffer_load_dwordx4 v[76:79], v16, s[28:31], s77 offen offset:1536 sc1
    buffer_load_dwordx4 v[80:83], v16, s[28:31], s77 offen offset:2048 sc1
    buffer_load_dwordx4 v[84:87], v16, s[28:31], s77 offen offset:2560 sc1
    buffer_load_dwordx4 v[88:91], v16, s[28:31], s77 offen offset:3072 sc1
    buffer_load_dwordx4 v[92:95], v16, s[28:31], s77 offen offset:3584 sc1
    s_waitcnt vmcnt(15)
    v_mfma_f32_16x16x32_bf16 v[56:59], v[96:99], v[128:131], v[56:59]
    s_waitcnt vmcnt(14)
    v_mfma_f32_16x16x32_bf16 v[56:59], v[100:103], v[132:135], v[56:59]
    s_waitcnt vmcnt(13)
    v_mfma_f32_16x16x32_bf16 v[56:59], v[104:107], v[136:139], v[56:59]
    s_waitcnt vmcnt(12)
    v_mfma_f32_16x16x32_bf16 v[56:59], v[108:111], v[140:143], v[56:59]
    s_waitcnt vmcnt(11)
    v_mfma_f32_16x16x32_bf16 v[56:59], v[112:115], v[144:147], v[56:59]
    s_waitcnt vmcnt(10)
    v_mfma_f32_16x16x32_bf16 v[56:59], v[116:119], v[148:151], v[56:59]
    s_waitcnt vmcnt(9)
    v_mfma_f32_16x16x32_bf16 v[56:59], v[120:123], v[152:155], v[56:59]
    s_waitcnt vmcnt(8)
    v_mfma_f32_16x16x32_bf16 v[56:59], v[124:127], v[156:159], v[56:59]
    s_waitcnt vmcnt(0)
    v_add_f32 v64, v64, v66
    v_add_f32 v68, v68, v70
    v_add_f32 v72, v72, v74
    v_add_f32 v76, v76, v78
    v_add_f32 v80, v80, v82
    v_add_f32 v84, v84, v86
    v_add_f32 v88, v88, v90
    v_add_f32 v92, v92, v94
    v_add_f32 v64, v64, v68
    v_add_f32 v72, v72, v76
    v_add_f32 v80, v80, v84
    v_add_f32 v88, v88, v92
    v_add_f32 v64, v64, v72
    v_add_f32 v80, v80, v88
    v_add_f32 v64, v64, v80
    v_add_f32 v65, v65, v67
    v_add_f32 v69, v69, v71
    v_add_f32 v73, v73, v75
    v_add_f32 v77, v77, v79
    v_add_f32 v81, v81, v83
    v_add_f32 v85, v85, v87
    v_add_f32 v89, v89, v91
    v_add_f32 v93, v93, v95
    v_add_f32 v65, v65, v69
    v_add_f32 v73, v73, v77
    v_add_f32 v81, v81, v85
    v_add_f32 v89, v89, v93
    v_add_f32 v65, v65, v73
    v_add_f32 v81, v81, v89
    v_add_f32 v65, v65, v81
    v_mul_f32 v30, 0x3b000000, v64
    v_mul_f32 v31, 0x3b000000, v65
    v_fma_f32 v31, -v30, v30, v31
    v_max_f32 v31, 0, v31
    v_cvt_pk_bf16_f32 v32, v30, v30
    v_cvt_pk_bf16_f32 v31, v31, v31
    v_xor_b32 v20, 0x80008000, v32
    v_and_b32 v31, 0xffff0000, v31
    v_and_b32 v21, 0xffff, v20
    v_add_f32 v31, 0x3727c5ac, v31
    v_cvt_pk_bf16_f32 v31, v31, v31
    v_and_b32 v31, 0xffff0000, v31
    v_sqrt_f32 v31, v31
    s_nop 0
    v_cvt_pk_bf16_f32 v31, v31, v31
    v_and_b32 v31, 0xffff0000, v31
    v_rcp_f32 v34, v31
    ds_read_b64 v[24:25], v17
    s_waitcnt lgkmcnt(0)
    v_mfma_f32_16x16x32_bf16 v[56:59], v[24:27], v[20:23], v[56:59]
    s_nop 7
    v_mul_f32 v56, v56, v34
    v_mul_f32 v57, v57, v34
    v_mul_f32 v58, v58, v34
    v_mul_f32 v59, v59, v34
    s_cmp_ge_u32 s52, 2
    s_cbranch_scc1 Lhv_H_3
    v_cvt_pk_bf16_f32 v30, v56, v57
    v_cvt_pk_bf16_f32 v31, v58, v59
    ds_write_b64 v19, v[30:31]
    s_branch Lhd_H_4
Lhv_H_3:
    ds_write_b128 v28, v[56:59]
Lhd_H_4:
    s_waitcnt lgkmcnt(0)
    s_barrier
    s_lshl_b32 s62, s52, 15
    s_lshl_b32 s63, s22, 11
    s_add_u32 s62, s62, s63
    s_add_u32 s62, s62, 720896
    buffer_load_dword v8, v1, s[28:31], s62 offen offset:0
    buffer_load_dword v8, v1, s[28:31], s62 offen offset:1024
    s_add_u32 s62, s56, s59
    s_add_u32 s62, s62, 262144
    s_add_u32 m0, s61, 49152
    s_nop 0
    buffer_load_dwordx4 v5, s[36:39], s62 offen lds
    s_add_u32 s62, s62, 8192
    s_add_u32 m0, m0, 1024
    s_nop 0
    buffer_load_dwordx4 v5, s[36:39], s62 offen lds
    s_add_u32 s62, s62, 8192
    s_add_u32 m0, m0, 1024
    s_nop 0
    buffer_load_dwordx4 v5, s[36:39], s62 offen lds
    s_add_u32 s62, s62, 8192
    s_add_u32 m0, m0, 1024
    s_nop 0
    buffer_load_dwordx4 v5, s[36:39], s62 offen lds
    s_add_u32 s62, s56, s59
    s_add_u32 s62, s62, 393216
    s_add_u32 m0, s61, 65536
    s_nop 0
    buffer_load_dwordx4 v5, s[36:39], s62 offen lds
    s_add_u32 s62, s62, 8192
    s_add_u32 m0, m0, 1024
    s_nop 0
    buffer_load_dwordx4 v5, s[36:39], s62 offen lds
    s_add_u32 s62, s62, 8192
    s_add_u32 m0, m0, 1024
    s_nop 0
    buffer_load_dwordx4 v5, s[36:39], s62 offen lds
    s_add_u32 s62, s62, 8192
    s_add_u32 m0, m0, 1024
    s_nop 0
    buffer_load_dwordx4 v5, s[36:39], s62 offen lds
    s_add_u32 s62, s52, 0
    s_mul_i32 s63, s62, 0x5556
    s_lshr_b32 s63, s63, 16
    s_mul_i32 s63, s63, 44032
    s_add_u32 s63, s63, s57
    s_add_u32 s63, s63, 0
    s_lshl_b32 s62, s62, 10
    s_add_u32 m0, s62, 81920
    s_nop 0
    buffer_load_dwordx4 v6, s[40:43], s63 offen lds
    s_add_u32 s62, s52, 4
    s_mul_i32 s63, s62, 0x5556
    s_lshr_b32 s63, s63, 16
    s_mul_i32 s63, s63, 44032
    s_add_u32 s63, s63, s57
    s_add_u32 s63, s63, 0
    s_lshl_b32 s62, s62, 10
    s_add_u32 m0, s62, 81920
    s_nop 0
    buffer_load_dwordx4 v10, s[40:43], s63 offen lds
    s_add_u32 s62, s52, 8
    s_mul_i32 s63, s62, 0x5556
    s_lshr_b32 s63, s63, 16
    s_mul_i32 s63, s63, 44032
    s_add_u32 s63, s63, s57
    s_add_u32 s63, s63, 0
    s_lshl_b32 s62, s62, 10
    s_add_u32 m0, s62, 81920
    s_nop 0
    buffer_load_dwordx4 v18, s[40:43], s63 offen lds
    s_add_u32 s62, s52, 12
    s_sub_u32 s63, s62, 3
    s_cmp_ge_u32 s62, 15
    s_cselect_b32 s62, s63, s62
    s_mul_i32 s63, s62, 0x5556
    s_lshr_b32 s63, s63, 16
    s_mul_i32 s63, s63, 44032
    s_add_u32 s63, s63, s57
    s_add_u32 s63, s63, 0
    s_lshl_b32 s62, s62, 10
    s_add_u32 m0, s62, 81920
    s_nop 0
    buffer_load_dwordx4 v6, s[40:43], s63 offen lds
    s_add_u32 s62, s52, 0
    s_mul_i32 s63, s62, 0x5556
    s_lshr_b32 s63, s63, 16
    s_mul_i32 s63, s63, 44032
    s_add_u32 s63, s63, s57
    s_add_u32 s63, s63, 0
    s_lshl_b32 s62, s62, 10
    s_add_u32 m0, s62, 98304
    s_nop 0
    buffer_load_dwordx4 v6, s[44:47], s63 offen lds
    s_add_u32 s62, s52, 4
    s_mul_i32 s63, s62, 0x5556
    s_lshr_b32 s63, s63, 16
    s_mul_i32 s63, s63, 44032
    s_add_u32 s63, s63, s57
    s_add_u32 s63, s63, 0
    s_lshl_b32 s62, s62, 10
    s_add_u32 m0, s62, 98304
    s_nop 0
    buffer_load_dwordx4 v10, s[44:47], s63 offen lds
    s_add_u32 s62, s52, 8
    s_mul_i32 s63, s62, 0x5556
    s_lshr_b32 s63, s63, 16
    s_mul_i32 s63, s63, 44032
    s_add_u32 s63, s63, s57
    s_add_u32 s63, s63, 0
    s_lshl_b32 s62, s62, 10
    s_add_u32 m0, s62, 98304
    s_nop 0
    buffer_load_dwordx4 v18, s[44:47], s63 offen lds
    s_add_u32 s62, s52, 12
    s_sub_u32 s63, s62, 3
    s_cmp_ge_u32 s62, 15
    s_cselect_b32 s62, s63, s62
    s_mul_i32 s63, s62, 0x5556
    s_lshr_b32 s63, s63, 16
    s_mul_i32 s63, s63, 44032
    s_add_u32 s63, s63, s57
    s_add_u32 s63, s63, 0
    s_lshl_b32 s62, s62, 10
    s_add_u32 m0, s62, 98304
    s_nop 0
    buffer_load_dwordx4 v6, s[44:47], s63 offen lds
    s_waitcnt vmcnt(8)
    s_barrier
    s_barrier
    s_add_u32 s62, s52, 0
    s_mul_i32 s63, s62, 0x5556
    s_lshr_b32 s63, s63, 16
    s_mul_i32 s63, s63, 44032
    s_add_u32 s63, s63, s57
    s_add_u32 s63, s63, 220160
    s_lshl_b32 s62, s62, 10
    s_add_u32 m0, s62, 114688
    s_nop 0
    buffer_load_dwordx4 v6, s[40:43], s63 offen lds
    s_add_u32 s62, s52, 4
    s_mul_i32 s63, s62, 0x5556
    s_lshr_b32 s63, s63, 16
    s_mul_i32 s63, s63, 44032
    s_add_u32 s63, s63, s57
    s_add_u32 s63, s63, 220160
    s_lshl_b32 s62, s62, 10
    s_add_u32 m0, s62, 114688
    s_nop 0
    buffer_load_dwordx4 v10, s[40:43], s63 offen lds
    s_add_u32 s62, s52, 8
    s_mul_i32 s63, s62, 0x5556
    s_lshr_b32 s63, s63, 16
    s_mul_i32 s63, s63, 44032
    s_add_u32 s63, s63, s57
    s_add_u32 s63, s63, 220160
    s_lshl_b32 s62, s62, 10
    s_add_u32 m0, s62, 114688
    s_nop 0
    buffer_load_dwordx4 v18, s[40:43], s63 offen lds
    s_add_u32 s62, s52, 12
    s_sub_u32 s63, s62, 3
    s_cmp_ge_u32 s62, 15
    s_cselect_b32 s62, s63, s62
    s_mul_i32 s63, s62, 0x5556
    s_lshr_b32 s63, s63, 16
    s_mul_i32 s63, s63, 44032
    s_add_u32 s63, s63, s57
    s_add_u32 s63, s63, 220160
    s_lshl_b32 s62, s62, 10
    s_add_u32 m0, s62, 114688
    s_nop 0
    buffer_load_dwordx4 v6, s[40:43], s63 offen lds
    s_add_u32 s62, s52, 0
    s_mul_i32 s63, s62, 0x5556
    s_lshr_b32 s63, s63, 16
    s_mul_i32 s63, s63, 44032
    s_add_u32 s63, s63, s57
    s_add_u32 s63, s63, 220160
    s_lshl_b32 s62, s62, 10
    s_add_u32 m0, s62, 0
    s_nop 0
    buffer_load_dwordx4 v6, s[44:47], s63 offen lds
    s_add_u32 s62, s52, 4
    s_mul_i32 s63, s62, 0x5556
    s_lshr_b32 s63, s63, 16
    s_mul_i32 s63, s63, 44032
    s_add_u32 s63, s63, s57
    s_add_u32 s63, s63, 220160
    s_lshl_b32 s62, s62, 10
    s_add_u32 m0, s62, 0
    s_nop 0
    buffer_load_dwordx4 v10, s[44:47], s63 offen lds
    s_add_u32 s62, s52, 8
    s_mul_i32 s63, s62, 0x5556
    s_lshr_b32 s63, s63, 16
    s_mul_i32 s63, s63, 44032
    s_add_u32 s63, s63, s57
    s_add_u32 s63, s63, 220160
    s_lshl_b32 s62, s62, 10
    s_add_u32 m0, s62, 0
    s_nop 0
    buffer_load_dwordx4 v18, s[44:47], s63 offen lds
    s_add_u32 s62, s52, 12
    s_sub_u32 s63, s62, 3
    s_cmp_ge_u32 s62, 15
    s_cselect_b32 s62, s63, s62
    s_mul_i32 s63, s62, 0x5556
    s_lshr_b32 s63, s63, 16
    s_mul_i32 s63, s63, 44032
    s_add_u32 s63, s63, s57
    s_add_u32 s63, s63, 220160
    s_lshl_b32 s62, s62, 10
    s_add_u32 m0, s62, 0
    s_nop 0
    buffer_load_dwordx4 v6, s[44:47], s63 offen lds
    s_barrier
    s_add_u32 s62, s52, 0
    s_lshl_b32 s62, s62, 10
    s_add_u32 s62, s62, 16384
    v_add_u32 v2, s62, v1
    ds_write_b128 v2, v[160:163]
    s_add_u32 s62, s52, 4
    s_lshl_b32 s62, s62, 10
    s_add_u32 s62, s62, 16384
    v_add_u32 v2, s62, v1
    ds_write_b128 v2, v[164:167]
    s_add_u32 s62, s52, 8
    s_lshl_b32 s62, s62, 10
    s_add_u32 s62, s62, 16384
    v_add_u32 v2, s62, v1
    ds_write_b128 v2, v[168:171]
    s_add_u32 s62, s52, 12
    s_sub_u32 s63, s62, 3
    s_cmp_ge_u32 s62, 15
    s_cselect_b32 s62, s63, s62
    s_lshl_b32 s62, s62, 10
    s_add_u32 s62, s62, 16384
    v_add_u32 v2, s62, v1
    ds_write_b128 v2, v[172:175]
    s_add_u32 s62, s52, 0
    s_lshl_b32 s62, s62, 10
    s_add_u32 s62, s62, 32768
    v_add_u32 v2, s62, v1
    ds_write_b128 v2, v[176:179]
    s_add_u32 s62, s52, 4
    s_lshl_b32 s62, s62, 10
    s_add_u32 s62, s62, 32768
    v_add_u32 v2, s62, v1
    ds_write_b128 v2, v[180:183]
    s_add_u32 s62, s52, 8
    s_lshl_b32 s62, s62, 10
    s_add_u32 s62, s62, 32768
    v_add_u32 v2, s62, v1
    ds_write_b128 v2, v[184:187]
    s_add_u32 s62, s52, 12
    s_sub_u32 s63, s62, 3
    s_cmp_ge_u32 s62, 15
    s_cselect_b32 s62, s63, s62
    s_lshl_b32 s62, s62, 10
    s_add_u32 s62, s62, 32768
    v_add_u32 v2, s62, v1
    ds_write_b128 v2, v[188:191]
    s_add_u32 s62, s52, 0
    s_lshl_b32 s62, s62, 10
    s_add_u32 s62, s62, 49152
    v_add_u32 v2, s62, v1
    ds_write_b128 v2, v[192:195]
    s_add_u32 s62, s52, 4
    s_lshl_b32 s62, s62, 10
    s_add_u32 s62, s62, 49152
    v_add_u32 v2, s62, v1
    ds_write_b128 v2, v[196:199]
    s_add_u32 s62, s52, 8
    s_lshl_b32 s62, s62, 10
    s_add_u32 s62, s62, 49152
    v_add_u32 v2, s62, v1
    ds_write_b128 v2, v[200:203]
    s_add_u32 s62, s52, 12
    s_sub_u32 s63, s62, 3
    s_cmp_ge_u32 s62, 15
    s_cselect_b32 s62, s63, s62
    s_lshl_b32 s62, s62, 10
    s_add_u32 s62, s62, 49152
    v_add_u32 v2, s62, v1
    ds_write_b128 v2, v[204:207]
    s_add_u32 s62, s52, 0
    s_lshl_b32 s62, s62, 10
    s_add_u32 s62, s62, 65536
    v_add_u32 v2, s62, v1
    ds_write_b128 v2, v[208:211]
    s_add_u32 s62, s52, 4
    s_lshl_b32 s62, s62, 10
    s_add_u32 s62, s62, 65536
    v_add_u32 v2, s62, v1
    ds_write_b128 v2, v[212:215]
    s_add_u32 s62, s52, 8
    s_lshl_b32 s62, s62, 10
    s_add_u32 s62, s62, 65536
    v_add_u32 v2, s62, v1
    s_waitcnt lgkmcnt(8)
    ds_write_b128 v2, v[216:219]
    s_add_u32 s62, s52, 12
    s_sub_u32 s63, s62, 3
    s_cmp_ge_u32 s62, 15
    s_cselect_b32 s62, s63, s62
    s_lshl_b32 s62, s62, 10
    s_add_u32 s62, s62, 65536
    v_add_u32 v2, s62, v1
    ds_write_b128 v2, v[220:223]
    s_waitcnt vmcnt(0)
    s_waitcnt lgkmcnt(0)
    s_barrier
    s_barrier
    s_add_u32 s62, s52, 0
    s_mul_i32 s63, s62, 0x5556
    s_lshr_b32 s63, s63, 16
    s_mul_i32 s63, s63, 44032
    s_add_u32 s63, s63, s57
    s_add_u32 s63, s63, 880640
    s_lshl_b32 s62, s62, 10
    s_add_u32 m0, s62, 81920
    s_nop 0
    buffer_load_dwordx4 v6, s[40:43], s63 offen lds
    s_add_u32 s62, s52, 4
    s_mul_i32 s63, s62, 0x5556
    s_lshr_b32 s63, s63, 16
    s_mul_i32 s63, s63, 44032
    s_add_u32 s63, s63, s57
    s_add_u32 s63, s63, 880640
    s_lshl_b32 s62, s62, 10
    s_add_u32 m0, s62, 81920
    s_nop 0
    buffer_load_dwordx4 v10, s[40:43], s63 offen lds
    s_add_u32 s62, s52, 8
    s_mul_i32 s63, s62, 0x5556
    s_lshr_b32 s63, s63, 16
    s_mul_i32 s63, s63, 44032
    s_add_u32 s63, s63, s57
    s_add_u32 s63, s63, 880640
    s_lshl_b32 s62, s62, 10
    s_add_u32 m0, s62, 81920
    s_nop 0
    buffer_load_dwordx4 v18, s[40:43], s63 offen lds
    s_add_u32 s62, s52, 12
    s_sub_u32 s63, s62, 3
    s_cmp_ge_u32 s62, 15
    s_cselect_b32 s62, s63, s62
    s_mul_i32 s63, s62, 0x5556
    s_lshr_b32 s63, s63, 16
    s_mul_i32 s63, s63, 44032
    s_add_u32 s63, s63, s57
    s_add_u32 s63, s63, 880640
    s_lshl_b32 s62, s62, 10
    s_add_u32 m0, s62, 81920
    s_nop 0
    buffer_load_dwordx4 v6, s[40:43], s63 offen lds
    s_add_u32 s62, s52, 0
    s_mul_i32 s63, s62, 0x5556
    s_lshr_b32 s63, s63, 16
    s_mul_i32 s63, s63, 44032
    s_add_u32 s63, s63, s57
    s_add_u32 s63, s63, 880640
    s_lshl_b32 s62, s62, 10
    s_add_u32 m0, s62, 98304
    s_nop 0
    buffer_load_dwordx4 v6, s[44:47], s63 offen lds
    s_add_u32 s62, s52, 4
    s_mul_i32 s63, s62, 0x5556
    s_lshr_b32 s63, s63, 16
    s_mul_i32 s63, s63, 44032
    s_add_u32 s63, s63, s57
    s_add_u32 s63, s63, 880640
    s_lshl_b32 s62, s62, 10
    s_add_u32 m0, s62, 98304
    s_nop 0
    buffer_load_dwordx4 v10, s[44:47], s63 offen lds
    s_add_u32 s62, s52, 8
    s_mul_i32 s63, s62, 0x5556
    s_lshr_b32 s63, s63, 16
    s_mul_i32 s63, s63, 44032
    s_add_u32 s63, s63, s57
    s_add_u32 s63, s63, 880640
    s_lshl_b32 s62, s62, 10
    s_add_u32 m0, s62, 98304
    s_nop 0
    buffer_load_dwordx4 v18, s[44:47], s63 offen lds
    s_add_u32 s62, s52, 12
    s_sub_u32 s63, s62, 3
    s_cmp_ge_u32 s62, 15
    s_cselect_b32 s62, s63, s62
    s_mul_i32 s63, s62, 0x5556
    s_lshr_b32 s63, s63, 16
    s_mul_i32 s63, s63, 44032
    s_add_u32 s63, s63, s57
    s_add_u32 s63, s63, 880640
    s_lshl_b32 s62, s62, 10
    s_add_u32 m0, s62, 98304
    s_nop 0
    buffer_load_dwordx4 v6, s[44:47], s63 offen lds
    s_barrier
    s_add_u32 s62, s52, 0
    s_mul_i32 s63, s62, 0x5556
    s_lshr_b32 s63, s63, 16
    s_mul_i32 s63, s63, 44032
    s_add_u32 s63, s63, s57
    s_add_u32 s63, s63, 1100800
    s_lshl_b32 s62, s62, 10
    s_add_u32 m0, s62, 114688
    s_nop 0
    buffer_load_dwordx4 v6, s[40:43], s63 offen lds
    s_add_u32 s62, s52, 4
    s_mul_i32 s63, s62, 0x5556
    s_lshr_b32 s63, s63, 16
    s_mul_i32 s63, s63, 44032
    s_add_u32 s63, s63, s57
    s_add_u32 s63, s63, 1100800
    s_lshl_b32 s62, s62, 10
    s_add_u32 m0, s62, 114688
    s_nop 0
    buffer_load_dwordx4 v10, s[40:43], s63 offen lds
    s_add_u32 s62, s52, 8
    s_mul_i32 s63, s62, 0x5556
    s_lshr_b32 s63, s63, 16
    s_mul_i32 s63, s63, 44032
    s_add_u32 s63, s63, s57
    s_add_u32 s63, s63, 1100800
    s_lshl_b32 s62, s62, 10
    s_add_u32 m0, s62, 114688
    s_nop 0
    buffer_load_dwordx4 v18, s[40:43], s63 offen lds
    s_add_u32 s62, s52, 12
    s_sub_u32 s63, s62, 3
    s_cmp_ge_u32 s62, 15
    s_cselect_b32 s62, s63, s62
    s_mul_i32 s63, s62, 0x5556
    s_lshr_b32 s63, s63, 16
    s_mul_i32 s63, s63, 44032
    s_add_u32 s63, s63, s57
    s_add_u32 s63, s63, 1100800
    s_lshl_b32 s62, s62, 10
    s_add_u32 m0, s62, 114688
    s_nop 0
    buffer_load_dwordx4 v6, s[40:43], s63 offen lds
    s_add_u32 s62, s52, 0
    s_mul_i32 s63, s62, 0x5556
    s_lshr_b32 s63, s63, 16
    s_mul_i32 s63, s63, 44032
    s_add_u32 s63, s63, s57
    s_add_u32 s63, s63, 1100800
    s_lshl_b32 s62, s62, 10
    s_add_u32 m0, s62, 0
    s_nop 0
    buffer_load_dwordx4 v6, s[44:47], s63 offen lds
    s_add_u32 s62, s52, 4
    s_mul_i32 s63, s62, 0x5556
    s_lshr_b32 s63, s63, 16
    s_mul_i32 s63, s63, 44032
    s_add_u32 s63, s63, s57
    s_add_u32 s63, s63, 1100800
    s_lshl_b32 s62, s62, 10
    s_add_u32 m0, s62, 0
    s_nop 0
    buffer_load_dwordx4 v10, s[44:47], s63 offen lds
    s_add_u32 s62, s52, 8
    s_mul_i32 s63, s62, 0x5556
    s_lshr_b32 s63, s63, 16
    s_mul_i32 s63, s63, 44032
    s_add_u32 s63, s63, s57
    s_add_u32 s63, s63, 1100800
    s_lshl_b32 s62, s62, 10
    s_add_u32 m0, s62, 0
    s_nop 0
    buffer_load_dwordx4 v18, s[44:47], s63 offen lds
    s_add_u32 s62, s52, 12
    s_sub_u32 s63, s62, 3
    s_cmp_ge_u32 s62, 15
    s_cselect_b32 s62, s63, s62
    s_mul_i32 s63, s62, 0x5556
    s_lshr_b32 s63, s63, 16
    s_mul_i32 s63, s63, 44032
    s_add_u32 s63, s63, s57
    s_add_u32 s63, s63, 1100800
    s_lshl_b32 s62, s62, 10
    s_add_u32 m0, s62, 0
    s_nop 0
    buffer_load_dwordx4 v6, s[44:47], s63 offen lds
    s_waitcnt vmcnt(8)
    s_barrier
    s_add_u32 s62, s52, 0
    s_mul_i32 s63, s62, 0x5556
    s_lshr_b32 s63, s63, 16
    s_mul_i32 s63, s63, 44032
    s_add_u32 s63, s63, s57
    s_add_u32 s63, s63, 1320960
    s_lshl_b32 s62, s62, 10
    s_add_u32 m0, s62, 16384
    s_nop 0
    buffer_load_dwordx4 v6, s[40:43], s63 offen lds
    s_add_u32 s62, s52, 4
    s_sub_u32 s63, s62, 3
    s_cmp_ge_u32 s62, 6
    s_cselect_b32 s62, s63, s62
    s_mul_i32 s63, s62, 0x5556
    s_lshr_b32 s63, s63, 16
    s_mul_i32 s63, s63, 44032
    s_add_u32 s63, s63, s57
    s_add_u32 s63, s63, 1320960
    s_lshl_b32 s62, s62, 10
    s_add_u32 m0, s62, 16384
    s_nop 0
    buffer_load_dwordx4 v10, s[40:43], s63 offen lds
    s_add_u32 s62, s52, 0
    s_mul_i32 s63, s62, 0x5556
    s_lshr_b32 s63, s63, 16
    s_mul_i32 s63, s63, 44032
    s_add_u32 s63, s63, s57
    s_add_u32 s63, s63, 1320960
    s_lshl_b32 s62, s62, 10
    s_add_u32 m0, s62, 32768
    s_nop 0
    buffer_load_dwordx4 v6, s[44:47], s63 offen lds
    s_add_u32 s62, s52, 4
    s_sub_u32 s63, s62, 3
    s_cmp_ge_u32 s62, 6
    s_cselect_b32 s62, s63, s62
    s_mul_i32 s63, s62, 0x5556
    s_lshr_b32 s63, s63, 16
    s_mul_i32 s63, s63, 44032
    s_add_u32 s63, s63, s57
    s_add_u32 s63, s63, 1320960
    s_lshl_b32 s62, s62, 10
    s_add_u32 m0, s62, 32768
    s_nop 0
    buffer_load_dwordx4 v10, s[44:47], s63 offen lds
    s_waitcnt vmcnt(4)
    s_barrier
    s_add_u32 s62, s56, s59
    s_add_u32 s62, s62, 0
    s_add_u32 m0, s61, 49152
    s_nop 0
    buffer_load_dwordx4 v5, s[48:51], s62 offen lds
    s_add_u32 s62, s62, 8192
    s_add_u32 m0, m0, 1024
    s_nop 0
    buffer_load_dwordx4 v5, s[48:51], s62 offen lds
    s_add_u32 s62, s62, 8192
    s_add_u32 m0, m0, 1024
    s_nop 0
    buffer_load_dwordx4 v5, s[48:51], s62 offen lds
    s_add_u32 s62, s62, 8192
    s_add_u32 m0, m0, 1024
    s_nop 0
    buffer_load_dwordx4 v5, s[48:51], s62 offen lds
    s_add_u32 s62, s56, s59
    s_add_u32 s62, s62, 704512
    s_add_u32 m0, s61, 65536
    s_nop 0
    buffer_load_dwordx4 v5, s[48:51], s62 offen lds
    s_add_u32 s62, s62, 8192
    s_add_u32 m0, m0, 1024
    s_nop 0
    buffer_load_dwordx4 v5, s[48:51], s62 offen lds
    s_add_u32 s62, s62, 8192
    s_add_u32 m0, m0, 1024
    s_nop 0
    buffer_load_dwordx4 v5, s[48:51], s62 offen lds
    s_add_u32 s62, s62, 8192
    s_add_u32 m0, m0, 1024
    s_nop 0
    buffer_load_dwordx4 v5, s[48:51], s62 offen lds
    s_waitcnt vmcnt(8)
    s_barrier
    s_add_u32 s62, s56, s59
    s_add_u32 s62, s62, 131072
    s_add_u32 m0, s61, 81920
    s_nop 0
    buffer_load_dwordx4 v5, s[48:51], s62 offen lds
    s_add_u32 s62, s62, 8192
    s_add_u32 m0, m0, 1024
    s_nop 0
    buffer_load_dwordx4 v5, s[48:51], s62 offen lds
    s_add_u32 s62, s62, 8192
    s_add_u32 m0, m0, 1024
    s_nop 0
    buffer_load_dwordx4 v5, s[48:51], s62 offen lds
    s_add_u32 s62, s62, 8192
    s_add_u32 m0, m0, 1024
    s_nop 0
    buffer_load_dwordx4 v5, s[48:51], s62 offen lds
    s_add_u32 s62, s56, s59
    s_add_u32 s62, s62, 835584
    s_add_u32 m0, s61, 98304
    s_nop 0
    buffer_load_dwordx4 v5, s[48:51], s62 offen lds
    s_add_u32 s62, s62, 8192
    s_add_u32 m0, m0, 1024
    s_nop 0
    buffer_load_dwordx4 v5, s[48:51], s62 offen lds
    s_add_u32 s62, s62, 8192
    s_add_u32 m0, m0, 1024
    s_nop 0
    buffer_load_dwordx4 v5, s[48:51], s62 offen lds
    s_add_u32 s62, s62, 8192
    s_add_u32 m0, m0, 1024
    s_nop 0
    buffer_load_dwordx4 v5, s[48:51], s62 offen lds
    s_barrier
    s_add_u32 s62, s56, s59
    s_add_u32 s62, s62, 262144
    s_add_u32 m0, s61, 114688
    s_nop 0
    buffer_load_dwordx4 v5, s[48:51], s62 offen lds
    s_add_u32 s62, s62, 8192
    s_add_u32 m0, m0, 1024
    s_nop 0
    buffer_load_dwordx4 v5, s[48:51], s62 offen lds
    s_add_u32 s62, s62, 8192
    s_add_u32 m0, m0, 1024
    s_nop 0
    buffer_load_dwordx4 v5, s[48:51], s62 offen lds
    s_add_u32 s62, s62, 8192
    s_add_u32 m0, m0, 1024
    s_nop 0
    buffer_load_dwordx4 v5, s[48:51], s62 offen lds
    s_add_u32 s62, s56, s59
    s_add_u32 s62, s62, 966656
    s_add_u32 m0, s61, 0
    s_nop 0
    buffer_load_dwordx4 v5, s[48:51], s62 offen lds
    s_add_u32 s62, s62, 8192
    s_add_u32 m0, m0, 1024
    s_nop 0
    buffer_load_dwordx4 v5, s[48:51], s62 offen lds
    s_add_u32 s62, s62, 8192
    s_add_u32 m0, m0, 1024
    s_nop 0
    buffer_load_dwordx4 v5, s[48:51], s62 offen lds
    s_add_u32 s62, s62, 8192
    s_add_u32 m0, m0, 1024
    s_nop 0
    buffer_load_dwordx4 v5, s[48:51], s62 offen lds
    s_barrier
    s_add_u32 s62, s56, s59
    s_add_u32 s62, s62, 393216
    s_add_u32 m0, s61, 16384
    s_nop 0
    buffer_load_dwordx4 v5, s[48:51], s62 offen lds
    s_add_u32 s62, s62, 8192
    s_add_u32 m0, m0, 1024
    s_nop 0
    buffer_load_dwordx4 v5, s[48:51], s62 offen lds
    s_add_u32 s62, s62, 8192
    s_add_u32 m0, m0, 1024
    s_nop 0
    buffer_load_dwordx4 v5, s[48:51], s62 offen lds
    s_add_u32 s62, s62, 8192
    s_add_u32 m0, m0, 1024
    s_nop 0
    buffer_load_dwordx4 v5, s[48:51], s62 offen lds
    s_add_u32 s62, s56, s59
    s_add_u32 s62, s62, 1097728
    s_add_u32 m0, s61, 32768
    s_nop 0
    buffer_load_dwordx4 v5, s[48:51], s62 offen lds
    s_add_u32 s62, s62, 8192
    s_add_u32 m0, m0, 1024
    s_nop 0
    buffer_load_dwordx4 v5, s[48:51], s62 offen lds
    s_add_u32 s62, s62, 8192
    s_add_u32 m0, m0, 1024
    s_nop 0
    buffer_load_dwordx4 v5, s[48:51], s62 offen lds
    s_add_u32 s62, s62, 8192
    s_add_u32 m0, m0, 1024
    s_nop 0
    buffer_load_dwordx4 v5, s[48:51], s62 offen lds
    s_waitcnt vmcnt(16)
    s_barrier
    s_waitcnt vmcnt(8)
    s_barrier
    v_add_u32 v2, 49152, v3
    ds_write_b128 v2, v[224:227] offset:0
    ds_write_b128 v2, v[228:231] offset:1024
    ds_write_b128 v2, v[232:235] offset:2048
    ds_write_b128 v2, v[236:239] offset:3072
    v_add_u32 v2, 65536, v3
    ds_write_b128 v2, v[240:243] offset:0
    ds_write_b128 v2, v[244:247] offset:1024
    ds_write_b128 v2, v[248:251] offset:2048
    ds_write_b128 v2, v[252:255] offset:3072
    s_waitcnt vmcnt(0)
    s_waitcnt lgkmcnt(0)
    s_barrier
    s_lshr_b32 s63, s52, 1
    s_mul_i32 s63, s63, 704512
    s_and_b32 s62, s52, 1
    s_mul_i32 s62, s62, 24576
    s_add_u32 s62, s62, s63
    s_add_u32 s62, s62, s56
    s_add_u32 s62, s62, 655360
    s_mul_i32 s63, s52, 3072
    s_add_u32 m0, s63, 81920
    s_nop 0
    buffer_load_dwordx4 v5, s[48:51], s62 offen lds
    s_add_u32 s62, s62, 8192
    s_add_u32 m0, m0, 1024
    s_nop 0
    buffer_load_dwordx4 v5, s[48:51], s62 offen lds
    s_add_u32 s62, s62, 8192
    s_add_u32 m0, m0, 1024
    s_nop 0
    buffer_load_dwordx4 v5, s[48:51], s62 offen lds
    s_barrier
    s_add_u32 s84, s16, 0
    s_addc_u32 s85, s17, 0
    s_mov_b32 s86, 2097152
    s_mov_b32 s87, 0x00020000
    s_lshl_b32 s62, s21, 2
    s_lshl_b32 s63, s53, 1
    s_add_u32 s62, s62, s63
    s_and_b32 s63, s52, 1
    s_add_u32 s62, s62, s63
    s_lshl_b32 s62, s62, 15
    s_lshl_b32 s63, s54, 7
    s_add_u32 s62, s62, s63
    s_lshr_b32 s63, s52, 1
    s_lshl_b32 s63, s63, 6
    s_add_u32 s62, s62, s63
    v_and_b32 v9, 31, v0
    v_lshlrev_b32 v9, 10, v9
    buffer_load_dword v8, v9, s[84:87], s62 offen
    s_waitcnt vmcnt(1)
    s_barrier
    s_barrier
    s_barrier
    s_branch L_fin
L_fin:
    s_waitcnt vmcnt(0) lgkmcnt(0)
L_end:
    s_endpgm
L_codeend:
.set CODE_LAST, (L_codeend - L_pc - 16) & 0xfffffff0
.section .rodata,"a"
.p2align 6
.amdhsa_kernel interleave_layers__sliding_local_dilated__geglu_ffn__prompt_kernel
  .amdhsa_next_free_vgpr 256
  .amdhsa_next_free_sgpr 100
  .amdhsa_accum_offset 256
  .amdhsa_group_segment_fixed_size 0
  .amdhsa_kernarg_size 80
  .amdhsa_user_sgpr_count 2
  .amdhsa_user_sgpr_kernarg_segment_ptr 1
  .amdhsa_system_sgpr_workgroup_id_x 1
.end_amdhsa_kernel
```
